```python
import torch

def _softmax(x, axis=-1):
    return torch.softmax(x, dim=axis)
def _gelu(x):
    return torch.nn.functional.gelu(x, approximate="tanh")
def _silu(x):
    return torch.nn.functional.silu(x)
def _sigmoid(x):
    return torch.sigmoid(x)
def _layernorm(x, axis=-1, eps=1e-5):
    m = x.mean(dim=axis, keepdim=True)
    v = x.var(dim=axis, keepdim=True, unbiased=False)
    return (x - m) / torch.sqrt(v + eps)
def _scatter_add(tgt, idx, src, axis=0):
    return tgt.clone().index_add_(axis, idx, src)
def _segment_sum(src, seg, n):
    out = torch.zeros((n,) + src.shape[1:], dtype=src.dtype)
    return out.index_add_(0, seg, src)
def _pad(x, pw):
    flat = tuple(v for pair in reversed(pw) for v in pair)
    return torch.nn.functional.pad(x, flat)

kernel_name = 'standalone__mha_block_cached__near_ridge'

def setup_inputs():

    _w = (lambda a: (lambda t: t.to(torch.bfloat16) if t.is_floating_point() else t)(torch.as_tensor(a)))
    B, Sq, D = 8, 128, 512
    H, Sk, Dh = 32, 128, 128
    return {
        "x": _w((lambda *s: torch.randn(*s, dtype=torch.bfloat16) * 0.8)(B, Sq, D)),
        "k_cache": _w((lambda *s: torch.randn(*s, dtype=torch.bfloat16) * 0.8)(B, H, Sk, Dh)),
        "v_cache": _w((lambda *s: torch.randn(*s, dtype=torch.bfloat16) * 0.05)(B, H, Sk, Dh)),
        "wq": _w((lambda *s: torch.randn(*s, dtype=torch.bfloat16) * 0.8)(D, H * Dh) * (D ** -0.5)),
        "wo": _w((lambda *s: torch.randn(*s, dtype=torch.bfloat16) * 0.05)(H * Dh, D) * ((H * Dh) ** -0.5)),
    }

def reference(x, k_cache, v_cache, wq, wo):
    B, Sq, D = x.shape
    H, Dh = 32, 128
    q = (lambda x, *d: x.permute(*d))((x @ wq).reshape(B, Sq, H, Dh), 0, 2, 1, 3)
    scores = torch.einsum("bhqd,bhkd->bhqk", q, k_cache) * (Dh ** -0.5)
    p = _softmax(scores, axis=-1)
    o = torch.einsum("bhqk,bhkd->bhqd", p, v_cache)
    return (lambda x, *d: x.permute(*d))(o, 0, 2, 1, 3).reshape(B, Sq, H * Dh) @ wo
```

```asm
; @launch grid=(256,1,1) block=(512,1,1) lds=163840
.amdgcn_target "amdgcn-amd-amdhsa--gfx950"
.text
.globl standalone__mha_block_cached__near_ridge_kernel
.p2align 8
.type standalone__mha_block_cached__near_ridge_kernel,@function
standalone__mha_block_cached__near_ridge_kernel:
    s_cmp_ge_u32 s2, 256
    s_cbranch_scc1 L_end
    s_load_dwordx16 s[16:31], s[0:1], 0
    v_lshrrev_b32 v2, 6, v0
    v_and_b32 v1, 63, v0
    v_readfirstlane_b32 s3, v2
    s_and_b32 s6, s2, 7
    s_lshr_b32 s65, s6, 1
    s_and_b32 s7, s6, 1
    s_lshr_b32 s5, s2, 3
    s_and_b32 s64, s5, 7
    s_lshl_b32 s4, s65, 3
    s_add_u32 s4, s4, s64
    s_lshr_b32 s5, s5, 3
    s_lshl_b32 s13, s5, 1
    s_add_u32 s15, s13, s64
    s_lshl_b32 s7, s7, 2
    s_add_u32 s5, s5, s7
    s_lshl_b32 s8, s5, 17
    s_lshl_b32 s69, s5, 5
    s_add_u32 s69, s69, s4
    s_cmp_lt_u32 s3, 4
    s_cbranch_scc1 L_compute
    s_sub_u32 s3, s3, 4
    s_lshl_b32 s9, s4, 8
    s_lshl_b32 s12, s3, 12
    v_lshrrev_b32 v3, 3, v1
    v_lshrrev_b32 v4, 4, v1
    v_and_b32 v7, 7, v1
    v_xor_b32 v8, v7, v4
    v_lshlrev_b32 v8, 4, v8
    s_lshl_b32 s6, s3, 5
    v_add_u32 v9, s6, v3
    v_lshlrev_b32 v5, 10, v9
    v_add_u32 v10, v5, v8
    v_add_u32 v11, 0x1c00, v10
    v_xor_b32 v11, 64, v11
    v_add_u32 v12, 0x3800, v10
    v_add_u32 v13, 0x5400, v10
    v_xor_b32 v13, 64, v13
    v_and_b32 v6, 15, v1
    v_lshlrev_b32 v8, 2, v4
    v_xor_b32 v8, v6, v8
    v_lshlrev_b32 v8, 4, v8
    s_lshl_b32 s7, s3, 4
    v_add_u32 v9, s7, v4
    v_lshl_add_u32 v14, v9, 13, v8
    v_add_u32 v15, 0x7c00, v14
    v_add_u32 v16, 0xf800, v14
    v_xor_b32 v16, 32, v16
    v_add_u32 v17, 0x17400, v14
    v_xor_b32 v17, 32, v17
    s_waitcnt lgkmcnt(0)
    s_mov_b32 s32, s16
    s_and_b32 s33, s17, 0xffff
    s_mov_b32 s34, 0x100000
    s_mov_b32 s35, 0x20000
    s_mov_b32 s44, s22
    s_and_b32 s45, s23, 0xffff
    s_mov_b32 s46, 0x400000
    s_mov_b32 s47, 0x20000
    s_add_u32 s6, s15, 0
    s_and_b32 s6, s6, 7
    s_lshl_b32 s7, s6, 7
    s_add_u32 m0, s12, 0x0
    s_add_u32 s14, s8, s7
    buffer_load_dwordx4 v10, s[32:35], s14 offen offset:0 lds
    buffer_load_dwordx4 v11, s[32:35], s14 offen offset:1024 lds
    buffer_load_dwordx4 v12, s[32:35], s14 offen offset:2048 lds
    buffer_load_dwordx4 v13, s[32:35], s14 offen offset:3072 lds
    s_add_u32 s6, s15, 0
    s_and_b32 s6, s6, 7
    s_lshl_b32 s7, s6, 19
    s_add_u32 m0, s12, 0x4000
    s_add_u32 s14, s9, s7
    buffer_load_dwordx4 v14, s[44:47], s14 offen offset:0 lds
    buffer_load_dwordx4 v15, s[44:47], s14 offen offset:1024 lds
    buffer_load_dwordx4 v16, s[44:47], s14 offen offset:2048 lds
    buffer_load_dwordx4 v17, s[44:47], s14 offen offset:3072 lds
    s_add_u32 s6, s15, 1
    s_and_b32 s6, s6, 7
    s_lshl_b32 s7, s6, 19
    s_add_u32 m0, s12, 0xc000
    s_add_u32 s14, s9, s7
    buffer_load_dwordx4 v14, s[44:47], s14 offen offset:0 lds
    buffer_load_dwordx4 v15, s[44:47], s14 offen offset:1024 lds
    buffer_load_dwordx4 v16, s[44:47], s14 offen offset:2048 lds
    buffer_load_dwordx4 v17, s[44:47], s14 offen offset:3072 lds
    s_branch L_lrest
    .p2align 3
L_compute:
    s_getpc_b64 s[66:67]
L_pc:
    s_sub_u32 s66, s66, L_pc-standalone__mha_block_cached__near_ridge_kernel
    s_subb_u32 s67, s67, 0
    v_lshlrev_b32 v4, 7, v0
    v_min_u32 v4, L_code_end-standalone__mha_block_cached__near_ridge_kernel-4, v4
    global_load_dword v5, v4, s[66:67]
    s_lshl_b32 s68, s69, 2
    s_add_u32 s68, s68, s3
    s_lshl_b32 s12, s3, 12
    v_lshlrev_b32 v23, 4, v1
    v_mov_b32 v28, 0
    v_and_b32 v2, 15, v1
    v_lshrrev_b32 v3, 4, v1
    v_bfe_u32 v4, v1, 2, 2
    v_and_b32 v6, 3, v1
    v_lshrrev_b32 v29, 5, v1
    v_and_b32 v30, 1, v3
    v_lshrrev_b32 v7, 1, v2
    v_xor_b32 v7, v7, v3
    v_lshlrev_b32 v7, 4, v7
    v_lshlrev_b32 v8, 7, v2
    v_add3_u32 v144, v7, v8, s12
    v_xor_b32 v145, 64, v144
    v_add_u32 v146, 0x10000, v144
    v_add_u32 v147, 0x10000, v145
    v_lshl_add_u32 v7, v3, 3, v4
    v_lshlrev_b32 v7, 8, v7
    v_lshl_add_u32 v7, v4, 6, v7
    v_lshl_add_u32 v7, v30, 5, v7
    v_lshl_add_u32 v7, v6, 3, v7
    v_add_u32 v128, 0x4000, v7
    v_xor_b32 v129, 32, v128
    v_xor_b32 v130, 64, v128
    v_xor_b32 v131, 96, v128
    v_xor_b32 v132, 128, v128
    v_xor_b32 v133, 160, v128
    v_xor_b32 v134, 192, v128
    v_xor_b32 v135, 224, v128
    v_add_u32 v136, 0x10000, v128
    v_add_u32 v137, 0x10000, v129
    v_add_u32 v138, 0x10000, v130
    v_add_u32 v139, 0x10000, v131
    v_add_u32 v140, 0x10000, v132
    v_add_u32 v141, 0x10000, v133
    v_add_u32 v142, 0x10000, v134
    v_add_u32 v143, 0x10000, v135
    s_waitcnt lgkmcnt(0)
    v_mov_b32 v24, 0x3f803f80
    v_mov_b32 v25, 0x3f803f80
    v_mov_b32 v26, 0x3f803f80
    v_mov_b32 v27, 0x3f803f80
    s_mov_b32 s60, s30
    s_and_b32 s61, s31, 0xffff
    s_mov_b32 s62, 0x10000000
    s_mov_b32 s63, 0x20000
    s_mov_b32 s56, s28
    s_and_b32 s57, s29, 0xffff
    s_mov_b32 s58, 0x100
    s_mov_b32 s59, 0x20000
    s_mov_b32 s52, s26
    s_and_b32 s53, s27, 0xffff
    s_mov_b32 s54, 0x100000
    s_mov_b32 s55, 0x20000
    s_cmp_lg_u32 s4, 0
    s_cbranch_scc1 L_noclr
    v_mov_b32 v200, 0
    v_mov_b32 v201, 0
    v_mov_b32 v202, 0
    v_mov_b32 v203, 0
    s_lshl_b32 s6, s5, 14
    s_add_u32 s6, s6, s12
    s_add_u32 s7, s6, 0x1020000
    s_add_u32 s6, s6, 0x1000000
    buffer_store_dwordx4 v[200:203], v23, s[60:63], s6 offen offset:0 sc1
    buffer_store_dwordx4 v[200:203], v23, s[60:63], s6 offen offset:1024 sc1
    buffer_store_dwordx4 v[200:203], v23, s[60:63], s6 offen offset:2048 sc1
    buffer_store_dwordx4 v[200:203], v23, s[60:63], s6 offen offset:3072 sc1
    buffer_store_dwordx4 v[200:203], v23, s[60:63], s7 offen offset:0 sc1
    buffer_store_dwordx4 v[200:203], v23, s[60:63], s7 offen offset:1024 sc1
    buffer_store_dwordx4 v[200:203], v23, s[60:63], s7 offen offset:2048 sc1
    buffer_store_dwordx4 v[200:203], v23, s[60:63], s7 offen offset:3072 sc1
L_noclr:
    s_nop 1
    s_barrier
    ds_read_b128 v[224:227], v144 offset:0
    ds_read_b128 v[228:231], v144 offset:2048
    ds_read_b64_tr_b16 v[32:33], v128 offset:0
    ds_read_b64_tr_b16 v[34:35], v128 offset:1024
    ds_read_b64_tr_b16 v[36:37], v129 offset:0
    ds_read_b64_tr_b16 v[38:39], v129 offset:1024
    ds_read_b64_tr_b16 v[40:41], v130 offset:0
    ds_read_b64_tr_b16 v[42:43], v130 offset:1024
    ds_read_b64_tr_b16 v[44:45], v131 offset:0
    ds_read_b64_tr_b16 v[46:47], v131 offset:1024
    s_waitcnt lgkmcnt(4)
    v_mfma_f32_16x16x32_bf16 v[64:67], v[32:35], v[224:227], 0
    ds_read_b64_tr_b16 v[48:49], v132 offset:0
    v_mfma_f32_16x16x32_bf16 v[68:71], v[32:35], v[228:231], 0
    ds_read_b64_tr_b16 v[50:51], v132 offset:1024
    v_mfma_f32_16x16x32_bf16 v[72:75], v[36:39], v[224:227], 0
    ds_read_b64_tr_b16 v[52:53], v133 offset:0
    v_mfma_f32_16x16x32_bf16 v[76:79], v[36:39], v[228:231], 0
    ds_read_b64_tr_b16 v[54:55], v133 offset:1024
    s_waitcnt lgkmcnt(4)
    v_mfma_f32_16x16x32_bf16 v[80:83], v[40:43], v[224:227], 0
    ds_read_b64_tr_b16 v[56:57], v134 offset:0
    v_mfma_f32_16x16x32_bf16 v[84:87], v[40:43], v[228:231], 0
    ds_read_b64_tr_b16 v[58:59], v134 offset:1024
    v_mfma_f32_16x16x32_bf16 v[88:91], v[44:47], v[224:227], 0
    ds_read_b64_tr_b16 v[60:61], v135 offset:0
    v_mfma_f32_16x16x32_bf16 v[92:95], v[44:47], v[228:231], 0
    ds_read_b64_tr_b16 v[62:63], v135 offset:1024
    s_waitcnt lgkmcnt(4)
    v_mfma_f32_16x16x32_bf16 v[96:99], v[48:51], v[224:227], 0
    ds_read_b128 v[232:235], v145 offset:0
    ds_read_b128 v[236:239], v145 offset:2048
    ds_read_b64_tr_b16 v[32:33], v128 offset:8192
    v_mfma_f32_16x16x32_bf16 v[100:103], v[48:51], v[228:231], 0
    ds_read_b64_tr_b16 v[34:35], v128 offset:9216
    v_mfma_f32_16x16x32_bf16 v[104:107], v[52:55], v[224:227], 0
    ds_read_b64_tr_b16 v[36:37], v129 offset:8192
    v_mfma_f32_16x16x32_bf16 v[108:111], v[52:55], v[228:231], 0
    ds_read_b64_tr_b16 v[38:39], v129 offset:9216
    s_waitcnt lgkmcnt(6)
    v_mfma_f32_16x16x32_bf16 v[112:115], v[56:59], v[224:227], 0
    ds_read_b64_tr_b16 v[40:41], v130 offset:8192
    v_mfma_f32_16x16x32_bf16 v[116:119], v[56:59], v[228:231], 0
    ds_read_b64_tr_b16 v[42:43], v130 offset:9216
    v_mfma_f32_16x16x32_bf16 v[120:123], v[60:63], v[224:227], 0
    ds_read_b64_tr_b16 v[44:45], v131 offset:8192
    v_mfma_f32_16x16x32_bf16 v[124:127], v[60:63], v[228:231], 0
    ds_read_b64_tr_b16 v[46:47], v131 offset:9216
    s_waitcnt lgkmcnt(4)
    v_mfma_f32_16x16x32_bf16 v[64:67], v[32:35], v[232:235], v[64:67]
    ds_read_b64_tr_b16 v[48:49], v132 offset:8192
    v_mfma_f32_16x16x32_bf16 v[68:71], v[32:35], v[236:239], v[68:71]
    ds_read_b64_tr_b16 v[50:51], v132 offset:9216
    v_mfma_f32_16x16x32_bf16 v[72:75], v[36:39], v[232:235], v[72:75]
    ds_read_b64_tr_b16 v[52:53], v133 offset:8192
    v_mfma_f32_16x16x32_bf16 v[76:79], v[36:39], v[236:239], v[76:79]
    ds_read_b64_tr_b16 v[54:55], v133 offset:9216
    s_waitcnt lgkmcnt(4)
    v_mfma_f32_16x16x32_bf16 v[80:83], v[40:43], v[232:235], v[80:83]
    ds_read_b64_tr_b16 v[56:57], v134 offset:8192
    v_mfma_f32_16x16x32_bf16 v[84:87], v[40:43], v[236:239], v[84:87]
    ds_read_b64_tr_b16 v[58:59], v134 offset:9216
    v_mfma_f32_16x16x32_bf16 v[88:91], v[44:47], v[232:235], v[88:91]
    ds_read_b64_tr_b16 v[60:61], v135 offset:8192
    v_mfma_f32_16x16x32_bf16 v[92:95], v[44:47], v[236:239], v[92:95]
    ds_read_b64_tr_b16 v[62:63], v135 offset:9216
    s_waitcnt lgkmcnt(0)
    s_barrier
    v_mfma_f32_16x16x32_bf16 v[96:99], v[48:51], v[232:235], v[96:99]
    ds_read_b128 v[224:227], v144 offset:32768
    ds_read_b128 v[228:231], v144 offset:34816
    ds_read_b64_tr_b16 v[32:33], v128 offset:32768
    v_mfma_f32_16x16x32_bf16 v[100:103], v[48:51], v[236:239], v[100:103]
    ds_read_b64_tr_b16 v[34:35], v128 offset:33792
    v_mfma_f32_16x16x32_bf16 v[104:107], v[52:55], v[232:235], v[104:107]
    ds_read_b64_tr_b16 v[36:37], v129 offset:32768
    v_mfma_f32_16x16x32_bf16 v[108:111], v[52:55], v[236:239], v[108:111]
    ds_read_b64_tr_b16 v[38:39], v129 offset:33792
    v_mfma_f32_16x16x32_bf16 v[112:115], v[56:59], v[232:235], v[112:115]
    ds_read_b64_tr_b16 v[40:41], v130 offset:32768
    v_mfma_f32_16x16x32_bf16 v[116:119], v[56:59], v[236:239], v[116:119]
    ds_read_b64_tr_b16 v[42:43], v130 offset:33792
    v_mfma_f32_16x16x32_bf16 v[120:123], v[60:63], v[232:235], v[120:123]
    ds_read_b64_tr_b16 v[44:45], v131 offset:32768
    v_mfma_f32_16x16x32_bf16 v[124:127], v[60:63], v[236:239], v[124:127]
    ds_read_b64_tr_b16 v[46:47], v131 offset:33792
    s_waitcnt lgkmcnt(4)
    v_mfma_f32_16x16x32_bf16 v[64:67], v[32:35], v[224:227], v[64:67]
    ds_read_b64_tr_b16 v[48:49], v132 offset:32768
    v_mfma_f32_16x16x32_bf16 v[68:71], v[32:35], v[228:231], v[68:71]
    ds_read_b64_tr_b16 v[50:51], v132 offset:33792
    v_mfma_f32_16x16x32_bf16 v[72:75], v[36:39], v[224:227], v[72:75]
    ds_read_b64_tr_b16 v[52:53], v133 offset:32768
    v_mfma_f32_16x16x32_bf16 v[76:79], v[36:39], v[228:231], v[76:79]
    ds_read_b64_tr_b16 v[54:55], v133 offset:33792
    s_waitcnt lgkmcnt(4)
    v_mfma_f32_16x16x32_bf16 v[80:83], v[40:43], v[224:227], v[80:83]
    ds_read_b64_tr_b16 v[56:57], v134 offset:32768
    v_mfma_f32_16x16x32_bf16 v[84:87], v[40:43], v[228:231], v[84:87]
    ds_read_b64_tr_b16 v[58:59], v134 offset:33792
    v_mfma_f32_16x16x32_bf16 v[88:91], v[44:47], v[224:227], v[88:91]
    ds_read_b64_tr_b16 v[60:61], v135 offset:32768
    v_mfma_f32_16x16x32_bf16 v[92:95], v[44:47], v[228:231], v[92:95]
    ds_read_b64_tr_b16 v[62:63], v135 offset:33792
    s_waitcnt lgkmcnt(4)
    v_mfma_f32_16x16x32_bf16 v[96:99], v[48:51], v[224:227], v[96:99]
    ds_read_b128 v[232:235], v145 offset:32768
    ds_read_b128 v[236:239], v145 offset:34816
    ds_read_b64_tr_b16 v[32:33], v128 offset:40960
    v_mfma_f32_16x16x32_bf16 v[100:103], v[48:51], v[228:231], v[100:103]
    ds_read_b64_tr_b16 v[34:35], v128 offset:41984
    v_mfma_f32_16x16x32_bf16 v[104:107], v[52:55], v[224:227], v[104:107]
    ds_read_b64_tr_b16 v[36:37], v129 offset:40960
    v_mfma_f32_16x16x32_bf16 v[108:111], v[52:55], v[228:231], v[108:111]
    ds_read_b64_tr_b16 v[38:39], v129 offset:41984
    s_waitcnt lgkmcnt(6)
    v_mfma_f32_16x16x32_bf16 v[112:115], v[56:59], v[224:227], v[112:115]
    ds_read_b64_tr_b16 v[40:41], v130 offset:40960
    v_mfma_f32_16x16x32_bf16 v[116:119], v[56:59], v[228:231], v[116:119]
    ds_read_b64_tr_b16 v[42:43], v130 offset:41984
    v_mfma_f32_16x16x32_bf16 v[120:123], v[60:63], v[224:227], v[120:123]
    ds_read_b64_tr_b16 v[44:45], v131 offset:40960
    v_mfma_f32_16x16x32_bf16 v[124:127], v[60:63], v[228:231], v[124:127]
    ds_read_b64_tr_b16 v[46:47], v131 offset:41984
    s_waitcnt lgkmcnt(4)
    v_mfma_f32_16x16x32_bf16 v[64:67], v[32:35], v[232:235], v[64:67]
    ds_read_b64_tr_b16 v[48:49], v132 offset:40960
    v_mfma_f32_16x16x32_bf16 v[68:71], v[32:35], v[236:239], v[68:71]
    ds_read_b64_tr_b16 v[50:51], v132 offset:41984
    v_mfma_f32_16x16x32_bf16 v[72:75], v[36:39], v[232:235], v[72:75]
    ds_read_b64_tr_b16 v[52:53], v133 offset:40960
    v_mfma_f32_16x16x32_bf16 v[76:79], v[36:39], v[236:239], v[76:79]
    ds_read_b64_tr_b16 v[54:55], v133 offset:41984
    s_waitcnt lgkmcnt(4)
    v_mfma_f32_16x16x32_bf16 v[80:83], v[40:43], v[232:235], v[80:83]
    ds_read_b64_tr_b16 v[56:57], v134 offset:40960
    v_mfma_f32_16x16x32_bf16 v[84:87], v[40:43], v[236:239], v[84:87]
    ds_read_b64_tr_b16 v[58:59], v134 offset:41984
    v_mfma_f32_16x16x32_bf16 v[88:91], v[44:47], v[232:235], v[88:91]
    ds_read_b64_tr_b16 v[60:61], v135 offset:40960
    v_mfma_f32_16x16x32_bf16 v[92:95], v[44:47], v[236:239], v[92:95]
    ds_read_b64_tr_b16 v[62:63], v135 offset:41984
    s_waitcnt lgkmcnt(0)
    s_barrier
    v_mfma_f32_16x16x32_bf16 v[96:99], v[48:51], v[232:235], v[96:99]
    ds_read_b128 v[224:227], v146 offset:0
    ds_read_b128 v[228:231], v146 offset:2048
    ds_read_b64_tr_b16 v[32:33], v136 offset:0
    v_mfma_f32_16x16x32_bf16 v[100:103], v[48:51], v[236:239], v[100:103]
    ds_read_b64_tr_b16 v[34:35], v136 offset:1024
    v_mfma_f32_16x16x32_bf16 v[104:107], v[52:55], v[232:235], v[104:107]
    ds_read_b64_tr_b16 v[36:37], v137 offset:0
    v_mfma_f32_16x16x32_bf16 v[108:111], v[52:55], v[236:239], v[108:111]
    ds_read_b64_tr_b16 v[38:39], v137 offset:1024
    v_mfma_f32_16x16x32_bf16 v[112:115], v[56:59], v[232:235], v[112:115]
    ds_read_b64_tr_b16 v[40:41], v138 offset:0
    v_mfma_f32_16x16x32_bf16 v[116:119], v[56:59], v[236:239], v[116:119]
    ds_read_b64_tr_b16 v[42:43], v138 offset:1024
    v_mfma_f32_16x16x32_bf16 v[120:123], v[60:63], v[232:235], v[120:123]
    ds_read_b64_tr_b16 v[44:45], v139 offset:0
    v_mfma_f32_16x16x32_bf16 v[124:127], v[60:63], v[236:239], v[124:127]
    ds_read_b64_tr_b16 v[46:47], v139 offset:1024
    s_waitcnt lgkmcnt(4)
    v_mfma_f32_16x16x32_bf16 v[64:67], v[32:35], v[224:227], v[64:67]
    ds_read_b64_tr_b16 v[48:49], v140 offset:0
    v_mfma_f32_16x16x32_bf16 v[68:71], v[32:35], v[228:231], v[68:71]
    ds_read_b64_tr_b16 v[50:51], v140 offset:1024
    v_mfma_f32_16x16x32_bf16 v[72:75], v[36:39], v[224:227], v[72:75]
    ds_read_b64_tr_b16 v[52:53], v141 offset:0
    v_mfma_f32_16x16x32_bf16 v[76:79], v[36:39], v[228:231], v[76:79]
    ds_read_b64_tr_b16 v[54:55], v141 offset:1024
    s_waitcnt lgkmcnt(4)
    v_mfma_f32_16x16x32_bf16 v[80:83], v[40:43], v[224:227], v[80:83]
    ds_read_b64_tr_b16 v[56:57], v142 offset:0
    v_mfma_f32_16x16x32_bf16 v[84:87], v[40:43], v[228:231], v[84:87]
    ds_read_b64_tr_b16 v[58:59], v142 offset:1024
    v_mfma_f32_16x16x32_bf16 v[88:91], v[44:47], v[224:227], v[88:91]
    ds_read_b64_tr_b16 v[60:61], v143 offset:0
    v_mfma_f32_16x16x32_bf16 v[92:95], v[44:47], v[228:231], v[92:95]
    ds_read_b64_tr_b16 v[62:63], v143 offset:1024
    s_waitcnt lgkmcnt(4)
    v_mfma_f32_16x16x32_bf16 v[96:99], v[48:51], v[224:227], v[96:99]
    ds_read_b128 v[232:235], v147 offset:0
    ds_read_b128 v[236:239], v147 offset:2048
    ds_read_b64_tr_b16 v[32:33], v136 offset:8192
    v_mfma_f32_16x16x32_bf16 v[100:103], v[48:51], v[228:231], v[100:103]
    ds_read_b64_tr_b16 v[34:35], v136 offset:9216
    v_mfma_f32_16x16x32_bf16 v[104:107], v[52:55], v[224:227], v[104:107]
    ds_read_b64_tr_b16 v[36:37], v137 offset:8192
    v_mfma_f32_16x16x32_bf16 v[108:111], v[52:55], v[228:231], v[108:111]
    ds_read_b64_tr_b16 v[38:39], v137 offset:9216
    s_waitcnt lgkmcnt(6)
    v_mfma_f32_16x16x32_bf16 v[112:115], v[56:59], v[224:227], v[112:115]
    ds_read_b64_tr_b16 v[40:41], v138 offset:8192
    v_mfma_f32_16x16x32_bf16 v[116:119], v[56:59], v[228:231], v[116:119]
    ds_read_b64_tr_b16 v[42:43], v138 offset:9216
    v_mfma_f32_16x16x32_bf16 v[120:123], v[60:63], v[224:227], v[120:123]
    ds_read_b64_tr_b16 v[44:45], v139 offset:8192
    v_mfma_f32_16x16x32_bf16 v[124:127], v[60:63], v[228:231], v[124:127]
    ds_read_b64_tr_b16 v[46:47], v139 offset:9216
    s_waitcnt lgkmcnt(4)
    v_mfma_f32_16x16x32_bf16 v[64:67], v[32:35], v[232:235], v[64:67]
    ds_read_b64_tr_b16 v[48:49], v140 offset:8192
    v_mfma_f32_16x16x32_bf16 v[68:71], v[32:35], v[236:239], v[68:71]
    ds_read_b64_tr_b16 v[50:51], v140 offset:9216
    v_mfma_f32_16x16x32_bf16 v[72:75], v[36:39], v[232:235], v[72:75]
    ds_read_b64_tr_b16 v[52:53], v141 offset:8192
    v_mfma_f32_16x16x32_bf16 v[76:79], v[36:39], v[236:239], v[76:79]
    ds_read_b64_tr_b16 v[54:55], v141 offset:9216
    s_waitcnt lgkmcnt(4)
    v_mfma_f32_16x16x32_bf16 v[80:83], v[40:43], v[232:235], v[80:83]
    ds_read_b64_tr_b16 v[56:57], v142 offset:8192
    v_mfma_f32_16x16x32_bf16 v[84:87], v[40:43], v[236:239], v[84:87]
    ds_read_b64_tr_b16 v[58:59], v142 offset:9216
    v_mfma_f32_16x16x32_bf16 v[88:91], v[44:47], v[232:235], v[88:91]
    ds_read_b64_tr_b16 v[60:61], v143 offset:8192
    v_mfma_f32_16x16x32_bf16 v[92:95], v[44:47], v[236:239], v[92:95]
    ds_read_b64_tr_b16 v[62:63], v143 offset:9216
    s_waitcnt lgkmcnt(0)
    s_barrier
    v_mfma_f32_16x16x32_bf16 v[96:99], v[48:51], v[232:235], v[96:99]
    ds_read_b128 v[224:227], v146 offset:32768
    ds_read_b128 v[228:231], v146 offset:34816
    ds_read_b64_tr_b16 v[32:33], v136 offset:32768
    v_mfma_f32_16x16x32_bf16 v[100:103], v[48:51], v[236:239], v[100:103]
    ds_read_b64_tr_b16 v[34:35], v136 offset:33792
    v_mfma_f32_16x16x32_bf16 v[104:107], v[52:55], v[232:235], v[104:107]
    ds_read_b64_tr_b16 v[36:37], v137 offset:32768
    v_mfma_f32_16x16x32_bf16 v[108:111], v[52:55], v[236:239], v[108:111]
    ds_read_b64_tr_b16 v[38:39], v137 offset:33792
    v_mfma_f32_16x16x32_bf16 v[112:115], v[56:59], v[232:235], v[112:115]
    ds_read_b64_tr_b16 v[40:41], v138 offset:32768
    v_mfma_f32_16x16x32_bf16 v[116:119], v[56:59], v[236:239], v[116:119]
    ds_read_b64_tr_b16 v[42:43], v138 offset:33792
    v_mfma_f32_16x16x32_bf16 v[120:123], v[60:63], v[232:235], v[120:123]
    ds_read_b64_tr_b16 v[44:45], v139 offset:32768
    v_mfma_f32_16x16x32_bf16 v[124:127], v[60:63], v[236:239], v[124:127]
    ds_read_b64_tr_b16 v[46:47], v139 offset:33792
    s_waitcnt lgkmcnt(4)
    v_mfma_f32_16x16x32_bf16 v[64:67], v[32:35], v[224:227], v[64:67]
    ds_read_b64_tr_b16 v[48:49], v140 offset:32768
    v_mfma_f32_16x16x32_bf16 v[68:71], v[32:35], v[228:231], v[68:71]
    ds_read_b64_tr_b16 v[50:51], v140 offset:33792
    v_xor_b32 v7, v29, v2
    v_lshlrev_b32 v7, 4, v7
    v_mfma_f32_16x16x32_bf16 v[72:75], v[36:39], v[224:227], v[72:75]
    ds_read_b64_tr_b16 v[52:53], v141 offset:32768
    v_mfma_f32_16x16x32_bf16 v[76:79], v[36:39], v[228:231], v[76:79]
    ds_read_b64_tr_b16 v[54:55], v141 offset:33792
    v_lshl_add_u32 v7, v2, 8, v7
    v_lshl_add_u32 v7, v30, 3, v7
    s_waitcnt lgkmcnt(4)
    v_mfma_f32_16x16x32_bf16 v[80:83], v[40:43], v[224:227], v[80:83]
    ds_read_b64_tr_b16 v[56:57], v142 offset:32768
    v_mfma_f32_16x16x32_bf16 v[84:87], v[40:43], v[228:231], v[84:87]
    ds_read_b64_tr_b16 v[58:59], v142 offset:33792
    v_add_u32 v10, 0x20000, v7
    v_xor_b32 v11, 32, v10
    v_mfma_f32_16x16x32_bf16 v[88:91], v[44:47], v[224:227], v[88:91]
    ds_read_b64_tr_b16 v[60:61], v143 offset:32768
    v_mfma_f32_16x16x32_bf16 v[92:95], v[44:47], v[228:231], v[92:95]
    ds_read_b64_tr_b16 v[62:63], v143 offset:33792
    v_xor_b32 v12, 64, v10
    v_xor_b32 v13, 96, v10
    s_waitcnt lgkmcnt(4)
    v_mfma_f32_16x16x32_bf16 v[96:99], v[48:51], v[224:227], v[96:99]
    ds_read_b128 v[232:235], v147 offset:32768
    ds_read_b128 v[236:239], v147 offset:34816
    ds_read_b64_tr_b16 v[32:33], v136 offset:40960
    v_mfma_f32_16x16x32_bf16 v[100:103], v[48:51], v[228:231], v[100:103]
    ds_read_b64_tr_b16 v[34:35], v136 offset:41984
    v_xor_b32 v14, 128, v10
    v_xor_b32 v15, 160, v10
    v_mfma_f32_16x16x32_bf16 v[104:107], v[52:55], v[224:227], v[104:107]
    ds_read_b64_tr_b16 v[36:37], v137 offset:40960
    v_mfma_f32_16x16x32_bf16 v[108:111], v[52:55], v[228:231], v[108:111]
    ds_read_b64_tr_b16 v[38:39], v137 offset:41984
    v_xor_b32 v16, 192, v10
    v_xor_b32 v17, 224, v10
    s_waitcnt lgkmcnt(6)
    v_mfma_f32_16x16x32_bf16 v[112:115], v[56:59], v[224:227], v[112:115]
    ds_read_b64_tr_b16 v[40:41], v138 offset:40960
    v_mfma_f32_16x16x32_bf16 v[116:119], v[56:59], v[228:231], v[116:119]
    ds_read_b64_tr_b16 v[42:43], v138 offset:41984
    v_lshl_add_u32 v7, v29, 3, v4
    v_lshlrev_b32 v7, 8, v7
    v_mfma_f32_16x16x32_bf16 v[120:123], v[60:63], v[224:227], v[120:123]
    ds_read_b64_tr_b16 v[44:45], v139 offset:40960
    v_mfma_f32_16x16x32_bf16 v[124:127], v[60:63], v[228:231], v[124:127]
    ds_read_b64_tr_b16 v[46:47], v139 offset:41984
    v_lshl_add_u32 v7, v4, 6, v7
    v_lshl_add_u32 v7, v30, 5, v7
    s_waitcnt lgkmcnt(4)
    v_mfma_f32_16x16x32_bf16 v[64:67], v[32:35], v[232:235], v[64:67]
    ds_read_b64_tr_b16 v[48:49], v140 offset:40960
    v_mfma_f32_16x16x32_bf16 v[68:71], v[32:35], v[236:239], v[68:71]
    ds_read_b64_tr_b16 v[50:51], v140 offset:41984
    v_lshl_add_u32 v18, v6, 3, v7
    v_xor_b32 v19, 64, v18
    v_mfma_f32_16x16x32_bf16 v[72:75], v[36:39], v[232:235], v[72:75]
    ds_read_b64_tr_b16 v[52:53], v141 offset:40960
    v_mfma_f32_16x16x32_bf16 v[76:79], v[36:39], v[236:239], v[76:79]
    ds_read_b64_tr_b16 v[54:55], v141 offset:41984
    v_xor_b32 v20, 128, v18
    v_xor_b32 v21, 192, v18
    s_waitcnt lgkmcnt(4)
    v_mfma_f32_16x16x32_bf16 v[80:83], v[40:43], v[232:235], v[80:83]
    ds_read_b64_tr_b16 v[56:57], v142 offset:40960
    v_mfma_f32_16x16x32_bf16 v[84:87], v[40:43], v[236:239], v[84:87]
    ds_read_b64_tr_b16 v[58:59], v142 offset:41984
    v_lshl_add_u32 v7, v29, 2, v4
    v_lshl_add_u32 v7, v30, 4, v7
    v_mfma_f32_16x16x32_bf16 v[88:91], v[44:47], v[232:235], v[88:91]
    ds_read_b64_tr_b16 v[60:61], v143 offset:40960
    v_mfma_f32_16x16x32_bf16 v[92:95], v[44:47], v[236:239], v[92:95]
    ds_read_b64_tr_b16 v[62:63], v143 offset:41984
    v_lshlrev_b32 v7, 7, v7
    v_lshrrev_b32 v8, 1, v4
    s_waitcnt lgkmcnt(0)
    s_barrier
    v_mfma_f32_16x16x32_bf16 v[96:99], v[48:51], v[232:235], v[96:99]
    ds_read_b128 v[224:227], v144 offset:0
    ds_read_b128 v[228:231], v144 offset:2048
    ds_read_b64_tr_b16 v[32:33], v128 offset:0
    v_mfma_f32_16x16x32_bf16 v[100:103], v[48:51], v[236:239], v[100:103]
    ds_read_b64_tr_b16 v[34:35], v128 offset:1024
    v_lshl_add_u32 v7, v8, 5, v7
    v_lshl_add_u32 v7, v30, 6, v7
    v_mfma_f32_16x16x32_bf16 v[104:107], v[52:55], v[232:235], v[104:107]
    ds_read_b64_tr_b16 v[36:37], v129 offset:0
    v_mfma_f32_16x16x32_bf16 v[108:111], v[52:55], v[236:239], v[108:111]
    ds_read_b64_tr_b16 v[38:39], v129 offset:1024
    v_lshl_add_u32 v7, v6, 3, v7
    v_add_u32 v240, 0x8000, v7
    v_mfma_f32_16x16x32_bf16 v[112:115], v[56:59], v[232:235], v[112:115]
    ds_read_b64_tr_b16 v[40:41], v130 offset:0
    v_mfma_f32_16x16x32_bf16 v[116:119], v[56:59], v[236:239], v[116:119]
    ds_read_b64_tr_b16 v[42:43], v130 offset:1024
    v_xor_b32 v241, 32, v240
    v_xor_b32 v242, 64, v240
    v_mfma_f32_16x16x32_bf16 v[120:123], v[60:63], v[232:235], v[120:123]
    ds_read_b64_tr_b16 v[44:45], v131 offset:0
    v_mfma_f32_16x16x32_bf16 v[124:127], v[60:63], v[236:239], v[124:127]
    ds_read_b64_tr_b16 v[46:47], v131 offset:1024
    v_xor_b32 v243, 96, v240
    v_lshlrev_b32 v22, 10, v2
    s_waitcnt lgkmcnt(4)
    v_mfma_f32_16x16x32_bf16 v[64:67], v[32:35], v[224:227], v[64:67]
    ds_read_b64_tr_b16 v[48:49], v132 offset:0
    v_mfma_f32_16x16x32_bf16 v[68:71], v[32:35], v[228:231], v[68:71]
    ds_read_b64_tr_b16 v[50:51], v132 offset:1024
    v_lshl_add_u32 v22, v30, 5, v22
    v_lshl_add_u32 v22, v29, 4, v22
    v_mfma_f32_16x16x32_bf16 v[72:75], v[36:39], v[224:227], v[72:75]
    ds_read_b64_tr_b16 v[52:53], v133 offset:0
    v_mfma_f32_16x16x32_bf16 v[76:79], v[36:39], v[228:231], v[76:79]
    ds_read_b64_tr_b16 v[54:55], v133 offset:1024
    s_sub_u32 s6, s64, s13
    s_add_u32 s6, s6, 0
    s_waitcnt lgkmcnt(4)
    v_mfma_f32_16x16x32_bf16 v[80:83], v[40:43], v[224:227], v[80:83]
    ds_read_b64_tr_b16 v[56:57], v134 offset:0
    v_mfma_f32_16x16x32_bf16 v[84:87], v[40:43], v[228:231], v[84:87]
    ds_read_b64_tr_b16 v[58:59], v134 offset:1024
    s_and_b32 s6, s6, 7
    s_lshl_b32 s32, s6, 14
    v_mfma_f32_16x16x32_bf16 v[88:91], v[44:47], v[224:227], v[88:91]
    ds_read_b64_tr_b16 v[60:61], v135 offset:0
    v_mfma_f32_16x16x32_bf16 v[92:95], v[44:47], v[228:231], v[92:95]
    ds_read_b64_tr_b16 v[62:63], v135 offset:1024
    s_sub_u32 s6, s64, s13
    s_add_u32 s6, s6, 1
    s_waitcnt lgkmcnt(4)
    v_mfma_f32_16x16x32_bf16 v[96:99], v[48:51], v[224:227], v[96:99]
    ds_read_b128 v[232:235], v145 offset:0
    ds_read_b128 v[236:239], v145 offset:2048
    ds_read_b64_tr_b16 v[32:33], v128 offset:8192
    v_mfma_f32_16x16x32_bf16 v[100:103], v[48:51], v[228:231], v[100:103]
    ds_read_b64_tr_b16 v[34:35], v128 offset:9216
    s_and_b32 s6, s6, 7
    s_lshl_b32 s33, s6, 14
    v_mfma_f32_16x16x32_bf16 v[104:107], v[52:55], v[224:227], v[104:107]
    ds_read_b64_tr_b16 v[36:37], v129 offset:8192
    v_mfma_f32_16x16x32_bf16 v[108:111], v[52:55], v[228:231], v[108:111]
    ds_read_b64_tr_b16 v[38:39], v129 offset:9216
    s_sub_u32 s6, s64, s13
    s_add_u32 s6, s6, 2
    s_waitcnt lgkmcnt(6)
    v_mfma_f32_16x16x32_bf16 v[112:115], v[56:59], v[224:227], v[112:115]
    ds_read_b64_tr_b16 v[40:41], v130 offset:8192
    v_mfma_f32_16x16x32_bf16 v[116:119], v[56:59], v[228:231], v[116:119]
    ds_read_b64_tr_b16 v[42:43], v130 offset:9216
    s_and_b32 s6, s6, 7
    s_lshl_b32 s34, s6, 14
    v_mfma_f32_16x16x32_bf16 v[120:123], v[60:63], v[224:227], v[120:123]
    ds_read_b64_tr_b16 v[44:45], v131 offset:8192
    v_mfma_f32_16x16x32_bf16 v[124:127], v[60:63], v[228:231], v[124:127]
    ds_read_b64_tr_b16 v[46:47], v131 offset:9216
    s_sub_u32 s6, s64, s13
    s_add_u32 s6, s6, 3
    s_waitcnt lgkmcnt(4)
    v_mfma_f32_16x16x32_bf16 v[64:67], v[32:35], v[232:235], v[64:67]
    ds_read_b64_tr_b16 v[48:49], v132 offset:8192
    v_mfma_f32_16x16x32_bf16 v[68:71], v[32:35], v[236:239], v[68:71]
    ds_read_b64_tr_b16 v[50:51], v132 offset:9216
    s_and_b32 s6, s6, 7
    s_lshl_b32 s35, s6, 14
    v_mfma_f32_16x16x32_bf16 v[72:75], v[36:39], v[232:235], v[72:75]
    ds_read_b64_tr_b16 v[52:53], v133 offset:8192
    v_mfma_f32_16x16x32_bf16 v[76:79], v[36:39], v[236:239], v[76:79]
    ds_read_b64_tr_b16 v[54:55], v133 offset:9216
    s_sub_u32 s6, s64, s13
    s_add_u32 s6, s6, 4
    s_waitcnt lgkmcnt(4)
    v_mfma_f32_16x16x32_bf16 v[80:83], v[40:43], v[232:235], v[80:83]
    ds_read_b64_tr_b16 v[56:57], v134 offset:8192
    v_mfma_f32_16x16x32_bf16 v[84:87], v[40:43], v[236:239], v[84:87]
    ds_read_b64_tr_b16 v[58:59], v134 offset:9216
    s_and_b32 s6, s6, 7
    s_lshl_b32 s36, s6, 14
    v_mfma_f32_16x16x32_bf16 v[88:91], v[44:47], v[232:235], v[88:91]
    ds_read_b64_tr_b16 v[60:61], v135 offset:8192
    v_mfma_f32_16x16x32_bf16 v[92:95], v[44:47], v[236:239], v[92:95]
    ds_read_b64_tr_b16 v[62:63], v135 offset:9216
    s_sub_u32 s6, s64, s13
    s_add_u32 s6, s6, 5
    s_waitcnt vmcnt(0)
    s_waitcnt lgkmcnt(0)
    s_barrier
    s_or_b32 s14, s4, s3
    s_cmp_lg_u32 s14, 0
    s_cbranch_scc1 L_noann
    s_lshl_b32 s14, s5, 5
    s_mov_b64 exec, 3
    buffer_store_dwordx4 v[24:27], v23, s[56:59], s14 offen sc1
    s_mov_b64 exec, -1
L_noann:
    s_nop 1
    v_mfma_f32_16x16x32_bf16 v[96:99], v[48:51], v[232:235], v[96:99]
    ds_read_b128 v[224:227], v144 offset:32768
    ds_read_b128 v[228:231], v144 offset:34816
    ds_read_b64_tr_b16 v[32:33], v128 offset:32768
    v_mfma_f32_16x16x32_bf16 v[100:103], v[48:51], v[236:239], v[100:103]
    ds_read_b64_tr_b16 v[34:35], v128 offset:33792
    s_and_b32 s6, s6, 7
    s_lshl_b32 s37, s6, 14
    v_mfma_f32_16x16x32_bf16 v[104:107], v[52:55], v[232:235], v[104:107]
    ds_read_b64_tr_b16 v[36:37], v129 offset:32768
    v_mfma_f32_16x16x32_bf16 v[108:111], v[52:55], v[236:239], v[108:111]
    ds_read_b64_tr_b16 v[38:39], v129 offset:33792
    s_sub_u32 s6, s64, s13
    s_add_u32 s6, s6, 6
    v_mfma_f32_16x16x32_bf16 v[112:115], v[56:59], v[232:235], v[112:115]
    ds_read_b64_tr_b16 v[40:41], v130 offset:32768
    v_mfma_f32_16x16x32_bf16 v[116:119], v[56:59], v[236:239], v[116:119]
    ds_read_b64_tr_b16 v[42:43], v130 offset:33792
    s_and_b32 s6, s6, 7
    s_lshl_b32 s38, s6, 14
    v_mfma_f32_16x16x32_bf16 v[120:123], v[60:63], v[232:235], v[120:123]
    ds_read_b64_tr_b16 v[44:45], v131 offset:32768
    v_mfma_f32_16x16x32_bf16 v[124:127], v[60:63], v[236:239], v[124:127]
    ds_read_b64_tr_b16 v[46:47], v131 offset:33792
    s_sub_u32 s6, s64, s13
    s_add_u32 s6, s6, 7
    s_waitcnt lgkmcnt(4)
    v_mfma_f32_16x16x32_bf16 v[64:67], v[32:35], v[224:227], v[64:67]
    ds_read_b64_tr_b16 v[48:49], v132 offset:32768
    v_mfma_f32_16x16x32_bf16 v[68:71], v[32:35], v[228:231], v[68:71]
    ds_read_b64_tr_b16 v[50:51], v132 offset:33792
    s_and_b32 s6, s6, 7
    s_lshl_b32 s39, s6, 14
    v_mfma_f32_16x16x32_bf16 v[72:75], v[36:39], v[224:227], v[72:75]
    ds_read_b64_tr_b16 v[52:53], v133 offset:32768
    v_mfma_f32_16x16x32_bf16 v[76:79], v[36:39], v[228:231], v[76:79]
    ds_read_b64_tr_b16 v[54:55], v133 offset:33792
    s_and_b32 s7, s68, 0xffffffe3
    s_lshl_b32 s40, s7, 13
    s_waitcnt lgkmcnt(4)
    v_mfma_f32_16x16x32_bf16 v[80:83], v[40:43], v[224:227], v[80:83]
    ds_read_b64_tr_b16 v[56:57], v134 offset:32768
    v_mfma_f32_16x16x32_bf16 v[84:87], v[40:43], v[228:231], v[84:87]
    ds_read_b64_tr_b16 v[58:59], v134 offset:33792
    s_lshl_b32 s6, s68, 7
    s_add_u32 s42, s6, 0x1000000
    v_mfma_f32_16x16x32_bf16 v[88:91], v[44:47], v[224:227], v[88:91]
    ds_read_b64_tr_b16 v[60:61], v135 offset:32768
    v_mfma_f32_16x16x32_bf16 v[92:95], v[44:47], v[228:231], v[92:95]
    ds_read_b64_tr_b16 v[62:63], v135 offset:33792
    s_add_u32 s47, s6, 0x1020000
    s_lshl_b32 s6, s7, 7
    s_waitcnt lgkmcnt(4)
    v_mfma_f32_16x16x32_bf16 v[96:99], v[48:51], v[224:227], v[96:99]
    ds_read_b128 v[232:235], v145 offset:32768
    ds_read_b128 v[236:239], v145 offset:34816
    ds_read_b64_tr_b16 v[32:33], v128 offset:40960
    v_mfma_f32_16x16x32_bf16 v[100:103], v[48:51], v[228:231], v[100:103]
    ds_read_b64_tr_b16 v[34:35], v128 offset:41984
    s_add_u32 s43, s6, 0x1000000
    s_lshl_b32 s6, 1, s64
    v_mfma_f32_16x16x32_bf16 v[104:107], v[52:55], v[224:227], v[104:107]
    ds_read_b64_tr_b16 v[36:37], v129 offset:40960
    v_mfma_f32_16x16x32_bf16 v[108:111], v[52:55], v[228:231], v[108:111]
    ds_read_b64_tr_b16 v[38:39], v129 offset:41984
    s_xor_b32 s44, s6, 0xff
    s_lshl_b32 s9, s68, 13
    s_waitcnt lgkmcnt(6)
    v_mfma_f32_16x16x32_bf16 v[112:115], v[56:59], v[224:227], v[112:115]
    ds_read_b64_tr_b16 v[40:41], v130 offset:40960
    v_mfma_f32_16x16x32_bf16 v[116:119], v[56:59], v[228:231], v[116:119]
    ds_read_b64_tr_b16 v[42:43], v130 offset:41984
    s_add_u32 s45, s9, 0x800000
    s_add_u32 s46, s45, 4096
    v_mfma_f32_16x16x32_bf16 v[120:123], v[60:63], v[224:227], v[120:123]
    ds_read_b64_tr_b16 v[44:45], v131 offset:40960
    v_mfma_f32_16x16x32_bf16 v[124:127], v[60:63], v[228:231], v[124:127]
    ds_read_b64_tr_b16 v[46:47], v131 offset:41984
    s_add_u32 s10, s9, 4096
    s_and_b32 s7, s68, 0xffffff9f
    s_waitcnt lgkmcnt(4)
    v_mfma_f32_16x16x32_bf16 v[64:67], v[32:35], v[232:235], v[64:67]
    ds_read_b64_tr_b16 v[48:49], v132 offset:40960
    v_mfma_f32_16x16x32_bf16 v[68:71], v[32:35], v[236:239], v[68:71]
    ds_read_b64_tr_b16 v[50:51], v132 offset:41984
    s_lshl_b32 s41, s7, 13
    s_add_u32 s41, s41, 0x800000
    v_mfma_f32_16x16x32_bf16 v[72:75], v[36:39], v[232:235], v[72:75]
    ds_read_b64_tr_b16 v[52:53], v133 offset:40960
    v_mfma_f32_16x16x32_bf16 v[76:79], v[36:39], v[236:239], v[76:79]
    ds_read_b64_tr_b16 v[54:55], v133 offset:41984
    s_lshl_b32 s7, s7, 7
    s_add_u32 s48, s7, 0x1020000
    s_waitcnt lgkmcnt(4)
    v_mfma_f32_16x16x32_bf16 v[80:83], v[40:43], v[232:235], v[80:83]
    ds_read_b64_tr_b16 v[56:57], v134 offset:40960
    v_mfma_f32_16x16x32_bf16 v[84:87], v[40:43], v[236:239], v[84:87]
    ds_read_b64_tr_b16 v[58:59], v134 offset:41984
    s_lshl_b32 s6, 1, s65
    s_xor_b32 s49, s6, 0xf
    v_mfma_f32_16x16x32_bf16 v[88:91], v[44:47], v[232:235], v[88:91]
    ds_read_b64_tr_b16 v[60:61], v135 offset:40960
    v_mfma_f32_16x16x32_bf16 v[92:95], v[44:47], v[236:239], v[92:95]
    ds_read_b64_tr_b16 v[62:63], v135 offset:41984
    s_lshl_b32 s6, s65, 15
    s_add_u32 s50, s8, s6
    s_waitcnt lgkmcnt(0)
    s_barrier
    v_mfma_f32_16x16x32_bf16 v[96:99], v[48:51], v[232:235], v[96:99]
    ds_read_b128 v[224:227], v146 offset:0
    ds_read_b128 v[228:231], v146 offset:2048
    ds_read_b64_tr_b16 v[32:33], v136 offset:0
    v_mfma_f32_16x16x32_bf16 v[100:103], v[48:51], v[236:239], v[100:103]
    ds_read_b64_tr_b16 v[34:35], v136 offset:1024
    s_lshl_b32 s6, s64, 7
    s_add_u32 s50, s50, s6
    v_mfma_f32_16x16x32_bf16 v[104:107], v[52:55], v[232:235], v[104:107]
    ds_read_b64_tr_b16 v[36:37], v137 offset:0
    v_mfma_f32_16x16x32_bf16 v[108:111], v[52:55], v[236:239], v[108:111]
    ds_read_b64_tr_b16 v[38:39], v137 offset:1024
    s_add_u32 s51, s50, 0x4000
    s_add_u32 s6, s64, 1
    v_mfma_f32_16x16x32_bf16 v[112:115], v[56:59], v[232:235], v[112:115]
    ds_read_b64_tr_b16 v[40:41], v138 offset:0
    v_mfma_f32_16x16x32_bf16 v[116:119], v[56:59], v[236:239], v[116:119]
    ds_read_b64_tr_b16 v[42:43], v138 offset:1024
    s_and_b32 s6, s6, 7
    s_lshl_b32 s6, s6, 15
    v_mfma_f32_16x16x32_bf16 v[120:123], v[60:63], v[232:235], v[120:123]
    ds_read_b64_tr_b16 v[44:45], v139 offset:0
    v_mfma_f32_16x16x32_bf16 v[124:127], v[60:63], v[236:239], v[124:127]
    ds_read_b64_tr_b16 v[46:47], v139 offset:1024
    s_add_u32 s16, s40, s6
    s_add_u32 s17, s16, 4096
    s_waitcnt lgkmcnt(4)
    v_mfma_f32_16x16x32_bf16 v[64:67], v[32:35], v[224:227], v[64:67]
    ds_read_b64_tr_b16 v[48:49], v140 offset:0
    v_mfma_f32_16x16x32_bf16 v[68:71], v[32:35], v[228:231], v[68:71]
    ds_read_b64_tr_b16 v[50:51], v140 offset:1024
    s_add_u32 s6, s64, 2
    s_and_b32 s6, s6, 7
    v_mfma_f32_16x16x32_bf16 v[72:75], v[36:39], v[224:227], v[72:75]
    ds_read_b64_tr_b16 v[52:53], v141 offset:0
    v_mfma_f32_16x16x32_bf16 v[76:79], v[36:39], v[228:231], v[76:79]
    ds_read_b64_tr_b16 v[54:55], v141 offset:1024
    s_lshl_b32 s6, s6, 15
    s_add_u32 s18, s40, s6
    s_waitcnt lgkmcnt(4)
    v_mfma_f32_16x16x32_bf16 v[80:83], v[40:43], v[224:227], v[80:83]
    ds_read_b64_tr_b16 v[56:57], v142 offset:0
    v_mfma_f32_16x16x32_bf16 v[84:87], v[40:43], v[228:231], v[84:87]
    ds_read_b64_tr_b16 v[58:59], v142 offset:1024
    s_add_u32 s19, s18, 4096
    s_add_u32 s6, s64, 3
    v_mfma_f32_16x16x32_bf16 v[88:91], v[44:47], v[224:227], v[88:91]
    ds_read_b64_tr_b16 v[60:61], v143 offset:0
    v_mfma_f32_16x16x32_bf16 v[92:95], v[44:47], v[228:231], v[92:95]
    ds_read_b64_tr_b16 v[62:63], v143 offset:1024
    s_and_b32 s6, s6, 7
    s_lshl_b32 s6, s6, 15
    s_waitcnt lgkmcnt(4)
    v_mfma_f32_16x16x32_bf16 v[96:99], v[48:51], v[224:227], v[96:99]
    ds_read_b128 v[232:235], v147 offset:0
    ds_read_b128 v[236:239], v147 offset:2048
    ds_read_b64_tr_b16 v[32:33], v136 offset:8192
    v_mfma_f32_16x16x32_bf16 v[100:103], v[48:51], v[228:231], v[100:103]
    ds_read_b64_tr_b16 v[34:35], v136 offset:9216
    s_add_u32 s20, s40, s6
    s_add_u32 s21, s20, 4096
    v_mfma_f32_16x16x32_bf16 v[104:107], v[52:55], v[224:227], v[104:107]
    ds_read_b64_tr_b16 v[36:37], v137 offset:8192
    v_mfma_f32_16x16x32_bf16 v[108:111], v[52:55], v[228:231], v[108:111]
    ds_read_b64_tr_b16 v[38:39], v137 offset:9216
    s_add_u32 s6, s64, 4
    s_and_b32 s6, s6, 7
    s_waitcnt lgkmcnt(6)
    v_mfma_f32_16x16x32_bf16 v[112:115], v[56:59], v[224:227], v[112:115]
    ds_read_b64_tr_b16 v[40:41], v138 offset:8192
    v_mfma_f32_16x16x32_bf16 v[116:119], v[56:59], v[228:231], v[116:119]
    ds_read_b64_tr_b16 v[42:43], v138 offset:9216
    s_lshl_b32 s6, s6, 15
    s_add_u32 s22, s40, s6
    v_mfma_f32_16x16x32_bf16 v[120:123], v[60:63], v[224:227], v[120:123]
    ds_read_b64_tr_b16 v[44:45], v139 offset:8192
    v_mfma_f32_16x16x32_bf16 v[124:127], v[60:63], v[228:231], v[124:127]
    ds_read_b64_tr_b16 v[46:47], v139 offset:9216
    s_add_u32 s23, s22, 4096
    s_add_u32 s6, s64, 5
    s_waitcnt lgkmcnt(4)
    v_mfma_f32_16x16x32_bf16 v[64:67], v[32:35], v[232:235], v[64:67]
    ds_read_b64_tr_b16 v[48:49], v140 offset:8192
    v_mfma_f32_16x16x32_bf16 v[68:71], v[32:35], v[236:239], v[68:71]
    ds_read_b64_tr_b16 v[50:51], v140 offset:9216
    s_and_b32 s6, s6, 7
    s_lshl_b32 s6, s6, 15
    v_mfma_f32_16x16x32_bf16 v[72:75], v[36:39], v[232:235], v[72:75]
    ds_read_b64_tr_b16 v[52:53], v141 offset:8192
    v_mfma_f32_16x16x32_bf16 v[76:79], v[36:39], v[236:239], v[76:79]
    ds_read_b64_tr_b16 v[54:55], v141 offset:9216
    s_add_u32 s24, s40, s6
    s_add_u32 s25, s24, 4096
    s_waitcnt lgkmcnt(4)
    v_mfma_f32_16x16x32_bf16 v[80:83], v[40:43], v[232:235], v[80:83]
    ds_read_b64_tr_b16 v[56:57], v142 offset:8192
    v_mfma_f32_16x16x32_bf16 v[84:87], v[40:43], v[236:239], v[84:87]
    ds_read_b64_tr_b16 v[58:59], v142 offset:9216
    s_add_u32 s6, s64, 6
    s_and_b32 s6, s6, 7
    v_mfma_f32_16x16x32_bf16 v[88:91], v[44:47], v[232:235], v[88:91]
    ds_read_b64_tr_b16 v[60:61], v143 offset:8192
    v_mfma_f32_16x16x32_bf16 v[92:95], v[44:47], v[236:239], v[92:95]
    ds_read_b64_tr_b16 v[62:63], v143 offset:9216
    s_lshl_b32 s6, s6, 15
    s_add_u32 s26, s40, s6
    s_waitcnt lgkmcnt(0)
    s_barrier
    v_mfma_f32_16x16x32_bf16 v[96:99], v[48:51], v[232:235], v[96:99]
    ds_read_b128 v[224:227], v146 offset:32768
    ds_read_b128 v[228:231], v146 offset:34816
    ds_read_b64_tr_b16 v[32:33], v136 offset:32768
    v_mfma_f32_16x16x32_bf16 v[100:103], v[48:51], v[236:239], v[100:103]
    ds_read_b64_tr_b16 v[34:35], v136 offset:33792
    s_add_u32 s27, s26, 4096
    s_add_u32 s6, s64, 7
    v_mfma_f32_16x16x32_bf16 v[104:107], v[52:55], v[232:235], v[104:107]
    ds_read_b64_tr_b16 v[36:37], v137 offset:32768
    v_mfma_f32_16x16x32_bf16 v[108:111], v[52:55], v[236:239], v[108:111]
    ds_read_b64_tr_b16 v[38:39], v137 offset:33792
    s_and_b32 s6, s6, 7
    s_lshl_b32 s6, s6, 15
    v_mfma_f32_16x16x32_bf16 v[112:115], v[56:59], v[232:235], v[112:115]
    ds_read_b64_tr_b16 v[40:41], v138 offset:32768
    v_mfma_f32_16x16x32_bf16 v[116:119], v[56:59], v[236:239], v[116:119]
    ds_read_b64_tr_b16 v[42:43], v138 offset:33792
    s_add_u32 s28, s40, s6
    s_add_u32 s29, s28, 4096
    v_mfma_f32_16x16x32_bf16 v[120:123], v[60:63], v[232:235], v[120:123]
    ds_read_b64_tr_b16 v[44:45], v139 offset:32768
    v_mfma_f32_16x16x32_bf16 v[124:127], v[60:63], v[236:239], v[124:127]
    ds_read_b64_tr_b16 v[46:47], v139 offset:33792
    s_waitcnt lgkmcnt(4)
    v_mfma_f32_16x16x32_bf16 v[64:67], v[32:35], v[224:227], v[64:67]
    ds_read_b64_tr_b16 v[48:49], v140 offset:32768
    v_mfma_f32_16x16x32_bf16 v[68:71], v[32:35], v[228:231], v[68:71]
    ds_read_b64_tr_b16 v[50:51], v140 offset:33792
    v_mfma_f32_16x16x32_bf16 v[72:75], v[36:39], v[224:227], v[72:75]
    ds_read_b64_tr_b16 v[52:53], v141 offset:32768
    v_mfma_f32_16x16x32_bf16 v[76:79], v[36:39], v[228:231], v[76:79]
    ds_read_b64_tr_b16 v[54:55], v141 offset:33792
    s_waitcnt lgkmcnt(4)
    v_mfma_f32_16x16x32_bf16 v[80:83], v[40:43], v[224:227], v[80:83]
    ds_read_b64_tr_b16 v[56:57], v142 offset:32768
    v_mfma_f32_16x16x32_bf16 v[84:87], v[40:43], v[228:231], v[84:87]
    ds_read_b64_tr_b16 v[58:59], v142 offset:33792
    v_mfma_f32_16x16x32_bf16 v[88:91], v[44:47], v[224:227], v[88:91]
    ds_read_b64_tr_b16 v[60:61], v143 offset:32768
    v_mfma_f32_16x16x32_bf16 v[92:95], v[44:47], v[228:231], v[92:95]
    ds_read_b64_tr_b16 v[62:63], v143 offset:33792
    s_waitcnt lgkmcnt(4)
    v_mfma_f32_16x16x32_bf16 v[96:99], v[48:51], v[224:227], v[96:99]
    ds_read_b128 v[232:235], v147 offset:32768
    ds_read_b128 v[236:239], v147 offset:34816
    ds_read_b64_tr_b16 v[32:33], v136 offset:40960
    v_mfma_f32_16x16x32_bf16 v[100:103], v[48:51], v[228:231], v[100:103]
    ds_read_b64_tr_b16 v[34:35], v136 offset:41984
    v_mfma_f32_16x16x32_bf16 v[104:107], v[52:55], v[224:227], v[104:107]
    ds_read_b64_tr_b16 v[36:37], v137 offset:40960
    v_mfma_f32_16x16x32_bf16 v[108:111], v[52:55], v[228:231], v[108:111]
    ds_read_b64_tr_b16 v[38:39], v137 offset:41984
    s_waitcnt lgkmcnt(6)
    v_mfma_f32_16x16x32_bf16 v[112:115], v[56:59], v[224:227], v[112:115]
    ds_read_b64_tr_b16 v[40:41], v138 offset:40960
    v_mfma_f32_16x16x32_bf16 v[116:119], v[56:59], v[228:231], v[116:119]
    ds_read_b64_tr_b16 v[42:43], v138 offset:41984
    v_mfma_f32_16x16x32_bf16 v[120:123], v[60:63], v[224:227], v[120:123]
    ds_read_b64_tr_b16 v[44:45], v139 offset:40960
    v_mfma_f32_16x16x32_bf16 v[124:127], v[60:63], v[228:231], v[124:127]
    ds_read_b64_tr_b16 v[46:47], v139 offset:41984
    s_waitcnt lgkmcnt(4)
    v_mfma_f32_16x16x32_bf16 v[64:67], v[32:35], v[232:235], v[64:67]
    ds_read_b64_tr_b16 v[48:49], v140 offset:40960
    v_mfma_f32_16x16x32_bf16 v[68:71], v[32:35], v[236:239], v[68:71]
    ds_read_b64_tr_b16 v[50:51], v140 offset:41984
    v_mfma_f32_16x16x32_bf16 v[72:75], v[36:39], v[232:235], v[72:75]
    ds_read_b64_tr_b16 v[52:53], v141 offset:40960
    v_mfma_f32_16x16x32_bf16 v[76:79], v[36:39], v[236:239], v[76:79]
    ds_read_b64_tr_b16 v[54:55], v141 offset:41984
    s_waitcnt lgkmcnt(4)
    v_mfma_f32_16x16x32_bf16 v[80:83], v[40:43], v[232:235], v[80:83]
    ds_read_b64_tr_b16 v[56:57], v142 offset:40960
    v_mfma_f32_16x16x32_bf16 v[84:87], v[40:43], v[236:239], v[84:87]
    ds_read_b64_tr_b16 v[58:59], v142 offset:41984
    v_mfma_f32_16x16x32_bf16 v[88:91], v[44:47], v[232:235], v[88:91]
    ds_read_b64_tr_b16 v[60:61], v143 offset:40960
    v_mfma_f32_16x16x32_bf16 v[92:95], v[44:47], v[236:239], v[92:95]
    ds_read_b64_tr_b16 v[62:63], v143 offset:41984
    s_waitcnt lgkmcnt(0)
    s_barrier
    v_mfma_f32_16x16x32_bf16 v[96:99], v[48:51], v[232:235], v[96:99]
    ds_read_b64 v[32:33], v10 offset:0
    v_mfma_f32_16x16x32_bf16 v[100:103], v[48:51], v[236:239], v[100:103]
    ds_read_b64 v[34:35], v11 offset:0
    v_mfma_f32_16x16x32_bf16 v[104:107], v[52:55], v[232:235], v[104:107]
    ds_read_b64 v[36:37], v12 offset:0
    v_mfma_f32_16x16x32_bf16 v[108:111], v[52:55], v[236:239], v[108:111]
    ds_read_b64 v[38:39], v13 offset:0
    v_mfma_f32_16x16x32_bf16 v[112:115], v[56:59], v[232:235], v[112:115]
    ds_read_b64 v[40:41], v14 offset:0
    v_mfma_f32_16x16x32_bf16 v[116:119], v[56:59], v[236:239], v[116:119]
    ds_read_b64 v[42:43], v15 offset:0
    v_mfma_f32_16x16x32_bf16 v[120:123], v[60:63], v[232:235], v[120:123]
    ds_read_b64 v[44:45], v16 offset:0
    v_mfma_f32_16x16x32_bf16 v[124:127], v[60:63], v[236:239], v[124:127]
    ds_read_b64 v[46:47], v17 offset:0
    v_cvt_pk_bf16_f32 v192, v64, v65
    v_cvt_pk_bf16_f32 v193, v66, v67
    v_cvt_pk_bf16_f32 v194, v72, v73
    v_cvt_pk_bf16_f32 v195, v74, v75
    v_cvt_pk_bf16_f32 v196, v68, v69
    v_cvt_pk_bf16_f32 v197, v70, v71
    v_cvt_pk_bf16_f32 v198, v76, v77
    v_cvt_pk_bf16_f32 v199, v78, v79
    s_waitcnt lgkmcnt(4)
    v_mfma_f32_16x16x32_bf16 v[128:131], v[32:35], v[192:195], 0
    ds_read_b64 v[48:49], v10 offset:4096
    v_cvt_pk_bf16_f32 v200, v80, v81
    v_cvt_pk_bf16_f32 v201, v82, v83
    v_cvt_pk_bf16_f32 v202, v88, v89
    v_cvt_pk_bf16_f32 v203, v90, v91
    v_mfma_f32_16x16x32_bf16 v[132:135], v[32:35], v[196:199], 0
    ds_read_b64 v[50:51], v11 offset:4096
    v_cvt_pk_bf16_f32 v204, v84, v85
    v_cvt_pk_bf16_f32 v205, v86, v87
    v_cvt_pk_bf16_f32 v206, v92, v93
    v_cvt_pk_bf16_f32 v207, v94, v95
    v_mfma_f32_16x16x32_bf16 v[128:131], v[36:39], v[200:203], v[128:131]
    ds_read_b64 v[52:53], v12 offset:4096
    v_cvt_pk_bf16_f32 v208, v96, v97
    v_cvt_pk_bf16_f32 v209, v98, v99
    v_cvt_pk_bf16_f32 v210, v104, v105
    v_cvt_pk_bf16_f32 v211, v106, v107
    v_mfma_f32_16x16x32_bf16 v[132:135], v[36:39], v[204:207], v[132:135]
    ds_read_b64 v[54:55], v13 offset:4096
    v_cvt_pk_bf16_f32 v212, v100, v101
    v_cvt_pk_bf16_f32 v213, v102, v103
    v_cvt_pk_bf16_f32 v214, v108, v109
    v_cvt_pk_bf16_f32 v215, v110, v111
    s_waitcnt lgkmcnt(4)
    v_mfma_f32_16x16x32_bf16 v[128:131], v[40:43], v[208:211], v[128:131]
    ds_read_b64 v[56:57], v14 offset:4096
    v_cvt_pk_bf16_f32 v216, v112, v113
    v_cvt_pk_bf16_f32 v217, v114, v115
    v_cvt_pk_bf16_f32 v218, v120, v121
    v_cvt_pk_bf16_f32 v219, v122, v123
    v_mfma_f32_16x16x32_bf16 v[132:135], v[40:43], v[212:215], v[132:135]
    ds_read_b64 v[58:59], v15 offset:4096
    v_cvt_pk_bf16_f32 v220, v116, v117
    v_cvt_pk_bf16_f32 v221, v118, v119
    v_cvt_pk_bf16_f32 v222, v124, v125
    v_cvt_pk_bf16_f32 v223, v126, v127
    v_mfma_f32_16x16x32_bf16 v[128:131], v[44:47], v[216:219], v[128:131]
    ds_read_b64 v[60:61], v16 offset:4096
    v_mfma_f32_16x16x32_bf16 v[132:135], v[44:47], v[220:223], v[132:135]
    ds_read_b64 v[62:63], v17 offset:4096
    s_waitcnt lgkmcnt(4)
    v_mfma_f32_16x16x32_bf16 v[136:139], v[48:51], v[192:195], 0
    ds_read_b64 v[32:33], v10 offset:8192
    v_mfma_f32_16x16x32_bf16 v[140:143], v[48:51], v[196:199], 0
    ds_read_b64 v[34:35], v11 offset:8192
    v_mfma_f32_16x16x32_bf16 v[136:139], v[52:55], v[200:203], v[136:139]
    ds_read_b64 v[36:37], v12 offset:8192
    v_mfma_f32_16x16x32_bf16 v[140:143], v[52:55], v[204:207], v[140:143]
    ds_read_b64 v[38:39], v13 offset:8192
    s_waitcnt lgkmcnt(4)
    v_mfma_f32_16x16x32_bf16 v[136:139], v[56:59], v[208:211], v[136:139]
    ds_read_b64 v[40:41], v14 offset:8192
    v_max3_f32 v29, v128, v129, v130
    v_mfma_f32_16x16x32_bf16 v[140:143], v[56:59], v[212:215], v[140:143]
    ds_read_b64 v[42:43], v15 offset:8192
    v_max_f32 v29, v29, v131
    v_mfma_f32_16x16x32_bf16 v[136:139], v[60:63], v[216:219], v[136:139]
    ds_read_b64 v[44:45], v16 offset:8192
    v_max3_f32 v30, v132, v133, v134
    v_mfma_f32_16x16x32_bf16 v[140:143], v[60:63], v[220:223], v[140:143]
    ds_read_b64 v[46:47], v17 offset:8192
    v_max_f32 v30, v30, v135
    s_waitcnt lgkmcnt(4)
    v_mfma_f32_16x16x32_bf16 v[144:147], v[32:35], v[192:195], 0
    ds_read_b64 v[48:49], v10 offset:12288
    v_mfma_f32_16x16x32_bf16 v[148:151], v[32:35], v[196:199], 0
    ds_read_b64 v[50:51], v11 offset:12288
    v_mfma_f32_16x16x32_bf16 v[144:147], v[36:39], v[200:203], v[144:147]
    ds_read_b64 v[52:53], v12 offset:12288
    v_mfma_f32_16x16x32_bf16 v[148:151], v[36:39], v[204:207], v[148:151]
    ds_read_b64 v[54:55], v13 offset:12288
    s_waitcnt lgkmcnt(4)
    v_mfma_f32_16x16x32_bf16 v[144:147], v[40:43], v[208:211], v[144:147]
    ds_read_b64 v[56:57], v14 offset:12288
    v_max3_f32 v29, v136, v137, v29
    v_mfma_f32_16x16x32_bf16 v[148:151], v[40:43], v[212:215], v[148:151]
    ds_read_b64 v[58:59], v15 offset:12288
    v_max3_f32 v29, v138, v139, v29
    v_mfma_f32_16x16x32_bf16 v[144:147], v[44:47], v[216:219], v[144:147]
    ds_read_b64 v[60:61], v16 offset:12288
    v_max3_f32 v30, v140, v141, v30
    v_mfma_f32_16x16x32_bf16 v[148:151], v[44:47], v[220:223], v[148:151]
    ds_read_b64 v[62:63], v17 offset:12288
    v_max3_f32 v30, v142, v143, v30
    s_waitcnt lgkmcnt(4)
    v_mfma_f32_16x16x32_bf16 v[152:155], v[48:51], v[192:195], 0
    ds_read_b64 v[32:33], v10 offset:16384
    v_mfma_f32_16x16x32_bf16 v[156:159], v[48:51], v[196:199], 0
    ds_read_b64 v[34:35], v11 offset:16384
    v_mfma_f32_16x16x32_bf16 v[152:155], v[52:55], v[200:203], v[152:155]
    ds_read_b64 v[36:37], v12 offset:16384
    v_mfma_f32_16x16x32_bf16 v[156:159], v[52:55], v[204:207], v[156:159]
    ds_read_b64 v[38:39], v13 offset:16384
    s_waitcnt lgkmcnt(4)
    v_mfma_f32_16x16x32_bf16 v[152:155], v[56:59], v[208:211], v[152:155]
    ds_read_b64 v[40:41], v14 offset:16384
    v_max3_f32 v29, v144, v145, v29
    v_mfma_f32_16x16x32_bf16 v[156:159], v[56:59], v[212:215], v[156:159]
    ds_read_b64 v[42:43], v15 offset:16384
    v_max3_f32 v29, v146, v147, v29
    v_mfma_f32_16x16x32_bf16 v[152:155], v[60:63], v[216:219], v[152:155]
    ds_read_b64 v[44:45], v16 offset:16384
    v_max3_f32 v30, v148, v149, v30
    v_mfma_f32_16x16x32_bf16 v[156:159], v[60:63], v[220:223], v[156:159]
    ds_read_b64 v[46:47], v17 offset:16384
    v_max3_f32 v30, v150, v151, v30
    s_waitcnt lgkmcnt(4)
    v_mfma_f32_16x16x32_bf16 v[160:163], v[32:35], v[192:195], 0
    ds_read_b64 v[48:49], v10 offset:20480
    v_mfma_f32_16x16x32_bf16 v[164:167], v[32:35], v[196:199], 0
    ds_read_b64 v[50:51], v11 offset:20480
    v_mfma_f32_16x16x32_bf16 v[160:163], v[36:39], v[200:203], v[160:163]
    ds_read_b64 v[52:53], v12 offset:20480
    v_mfma_f32_16x16x32_bf16 v[164:167], v[36:39], v[204:207], v[164:167]
    ds_read_b64 v[54:55], v13 offset:20480
    s_waitcnt lgkmcnt(4)
    v_mfma_f32_16x16x32_bf16 v[160:163], v[40:43], v[208:211], v[160:163]
    ds_read_b64 v[56:57], v14 offset:20480
    v_max3_f32 v29, v152, v153, v29
    v_mfma_f32_16x16x32_bf16 v[164:167], v[40:43], v[212:215], v[164:167]
    ds_read_b64 v[58:59], v15 offset:20480
    v_max3_f32 v29, v154, v155, v29
    v_mfma_f32_16x16x32_bf16 v[160:163], v[44:47], v[216:219], v[160:163]
    ds_read_b64 v[60:61], v16 offset:20480
    v_max3_f32 v30, v156, v157, v30
    v_mfma_f32_16x16x32_bf16 v[164:167], v[44:47], v[220:223], v[164:167]
    ds_read_b64 v[62:63], v17 offset:20480
    v_max3_f32 v30, v158, v159, v30
    s_waitcnt lgkmcnt(4)
    v_mfma_f32_16x16x32_bf16 v[168:171], v[48:51], v[192:195], 0
    ds_read_b64 v[32:33], v10 offset:24576
    v_mfma_f32_16x16x32_bf16 v[172:175], v[48:51], v[196:199], 0
    ds_read_b64 v[34:35], v11 offset:24576
    v_mfma_f32_16x16x32_bf16 v[168:171], v[52:55], v[200:203], v[168:171]
    ds_read_b64 v[36:37], v12 offset:24576
    v_mfma_f32_16x16x32_bf16 v[172:175], v[52:55], v[204:207], v[172:175]
    ds_read_b64 v[38:39], v13 offset:24576
    s_waitcnt lgkmcnt(4)
    v_mfma_f32_16x16x32_bf16 v[168:171], v[56:59], v[208:211], v[168:171]
    ds_read_b64 v[40:41], v14 offset:24576
    v_max3_f32 v29, v160, v161, v29
    v_mfma_f32_16x16x32_bf16 v[172:175], v[56:59], v[212:215], v[172:175]
    ds_read_b64 v[42:43], v15 offset:24576
    v_max3_f32 v29, v162, v163, v29
    v_mfma_f32_16x16x32_bf16 v[168:171], v[60:63], v[216:219], v[168:171]
    ds_read_b64 v[44:45], v16 offset:24576
    v_max3_f32 v30, v164, v165, v30
    v_mfma_f32_16x16x32_bf16 v[172:175], v[60:63], v[220:223], v[172:175]
    ds_read_b64 v[46:47], v17 offset:24576
    v_max3_f32 v30, v166, v167, v30
    s_waitcnt lgkmcnt(4)
    v_mfma_f32_16x16x32_bf16 v[176:179], v[32:35], v[192:195], 0
    ds_read_b64 v[48:49], v10 offset:28672
    v_mfma_f32_16x16x32_bf16 v[180:183], v[32:35], v[196:199], 0
    ds_read_b64 v[50:51], v11 offset:28672
    v_mfma_f32_16x16x32_bf16 v[176:179], v[36:39], v[200:203], v[176:179]
    ds_read_b64 v[52:53], v12 offset:28672
    v_mfma_f32_16x16x32_bf16 v[180:183], v[36:39], v[204:207], v[180:183]
    ds_read_b64 v[54:55], v13 offset:28672
    s_waitcnt lgkmcnt(4)
    v_mfma_f32_16x16x32_bf16 v[176:179], v[40:43], v[208:211], v[176:179]
    ds_read_b64 v[56:57], v14 offset:28672
    v_max3_f32 v29, v168, v169, v29
    v_mfma_f32_16x16x32_bf16 v[180:183], v[40:43], v[212:215], v[180:183]
    ds_read_b64 v[58:59], v15 offset:28672
    v_max3_f32 v29, v170, v171, v29
    v_mfma_f32_16x16x32_bf16 v[176:179], v[44:47], v[216:219], v[176:179]
    ds_read_b64 v[60:61], v16 offset:28672
    v_max3_f32 v30, v172, v173, v30
    v_mfma_f32_16x16x32_bf16 v[180:183], v[44:47], v[220:223], v[180:183]
    ds_read_b64 v[62:63], v17 offset:28672
    v_max3_f32 v30, v174, v175, v30
    s_waitcnt lgkmcnt(4)
    v_mfma_f32_16x16x32_bf16 v[184:187], v[48:51], v[192:195], 0
    v_mfma_f32_16x16x32_bf16 v[188:191], v[48:51], v[196:199], 0
    v_mfma_f32_16x16x32_bf16 v[184:187], v[52:55], v[200:203], v[184:187]
    v_mfma_f32_16x16x32_bf16 v[188:191], v[52:55], v[204:207], v[188:191]
    s_waitcnt lgkmcnt(0)
    v_mfma_f32_16x16x32_bf16 v[184:187], v[56:59], v[208:211], v[184:187]
    v_max3_f32 v29, v176, v177, v29
    v_mfma_f32_16x16x32_bf16 v[188:191], v[56:59], v[212:215], v[188:191]
    v_max3_f32 v29, v178, v179, v29
    v_mfma_f32_16x16x32_bf16 v[184:187], v[60:63], v[216:219], v[184:187]
    v_max3_f32 v30, v180, v181, v30
    v_mfma_f32_16x16x32_bf16 v[188:191], v[60:63], v[220:223], v[188:191]
    v_max3_f32 v30, v182, v183, v30
    s_lshl_b32 s6, s5, 5
    s_cmp_lg_u32 s3, 0
    s_cbranch_scc1 L_nohs
    buffer_load_dword v6, v28, s[56:59], s6 offen sc1
L_nohs:
    s_mov_b32 s67, 0x3e0293ee
    s_barrier
    ds_read_b64_tr_b16 v[32:33], v18 offset:0
    ds_read_b64_tr_b16 v[34:35], v18 offset:1024
    ds_read_b64_tr_b16 v[36:37], v19 offset:0
    ds_read_b64_tr_b16 v[38:39], v19 offset:1024
    ds_read_b64_tr_b16 v[40:41], v20 offset:0
    ds_read_b64_tr_b16 v[42:43], v20 offset:1024
    ds_read_b64_tr_b16 v[44:45], v21 offset:0
    ds_read_b64_tr_b16 v[46:47], v21 offset:1024
    v_max3_f32 v29, v184, v185, v29
    v_max3_f32 v29, v186, v187, v29
    v_max3_f32 v30, v188, v189, v30
    v_max3_f32 v30, v190, v191, v30
    s_nop 1
    v_permlane16_swap_b32 v29, v30
    v_max_f32 v29, v29, v30
    v_mov_b32 v30, v29
    s_nop 1
    v_permlane32_swap_b32 v30, v29
    v_max_f32 v29, v29, v30
    v_mul_f32 v29, s67, v29
    v_mov_b32 v30, v29
    s_nop 1
    v_permlane16_swap_b32 v29, v30
    v_fma_f32 v128, v128, s67, -v29
    v_fma_f32 v129, v129, s67, -v29
    v_fma_f32 v130, v130, s67, -v29
    v_fma_f32 v131, v131, s67, -v29
    v_fma_f32 v132, v132, s67, -v30
    v_fma_f32 v133, v133, s67, -v30
    v_fma_f32 v134, v134, s67, -v30
    v_fma_f32 v135, v135, s67, -v30
    v_exp_f32 v128, v128
    v_exp_f32 v129, v129
    v_exp_f32 v130, v130
    v_exp_f32 v131, v131
    v_exp_f32 v132, v132
    v_exp_f32 v133, v133
    v_exp_f32 v134, v134
    v_exp_f32 v135, v135
    v_cvt_pk_bf16_f32 v192, v128, v129
    v_cvt_pk_bf16_f32 v193, v130, v131
    v_cvt_pk_bf16_f32 v194, v132, v133
    v_cvt_pk_bf16_f32 v195, v134, v135
    v_fma_f32 v136, v136, s67, -v29
    v_fma_f32 v137, v137, s67, -v29
    v_permlane16_swap_b32 v192, v194
    v_permlane16_swap_b32 v193, v195
    v_fma_f32 v138, v138, s67, -v29
    v_fma_f32 v139, v139, s67, -v29
    s_waitcnt lgkmcnt(0)
    v_mfma_f32_32x32x16_bf16 v[64:79], v[32:35], v[192:195], 0
    ds_read_b64_tr_b16 v[48:49], v18 offset:4096
    ds_read_b64_tr_b16 v[50:51], v18 offset:5120
    v_mfma_f32_32x32x16_bf16 v[224:239], v[24:27], v[192:195], 0
    v_fma_f32 v140, v140, s67, -v30
    v_fma_f32 v141, v141, s67, -v30
    v_fma_f32 v142, v142, s67, -v30
    v_fma_f32 v143, v143, s67, -v30
    v_exp_f32 v136, v136
    v_mfma_f32_32x32x16_bf16 v[80:95], v[36:39], v[192:195], 0
    ds_read_b64_tr_b16 v[52:53], v19 offset:4096
    ds_read_b64_tr_b16 v[54:55], v19 offset:5120
    v_exp_f32 v137, v137
    v_exp_f32 v138, v138
    v_exp_f32 v139, v139
    v_exp_f32 v140, v140
    v_exp_f32 v141, v141
    v_exp_f32 v142, v142
    v_mfma_f32_32x32x16_bf16 v[96:111], v[40:43], v[192:195], 0
    ds_read_b64_tr_b16 v[56:57], v20 offset:4096
    ds_read_b64_tr_b16 v[58:59], v20 offset:5120
    v_exp_f32 v143, v143
    v_cvt_pk_bf16_f32 v196, v136, v137
    v_cvt_pk_bf16_f32 v197, v138, v139
    v_cvt_pk_bf16_f32 v198, v140, v141
    v_cvt_pk_bf16_f32 v199, v142, v143
    v_fma_f32 v144, v144, s67, -v29
    v_mfma_f32_32x32x16_bf16 v[112:127], v[44:47], v[192:195], 0
    ds_read_b64_tr_b16 v[60:61], v21 offset:4096
    ds_read_b64_tr_b16 v[62:63], v21 offset:5120
    v_fma_f32 v145, v145, s67, -v29
    v_permlane16_swap_b32 v196, v198
    v_permlane16_swap_b32 v197, v199
    v_fma_f32 v146, v146, s67, -v29
    v_fma_f32 v147, v147, s67, -v29
    v_mfma_f32_32x32x16_bf16 v[224:239], v[24:27], v[196:199], v[224:239]
    s_waitcnt lgkmcnt(0)
    v_mfma_f32_32x32x16_bf16 v[64:79], v[48:51], v[196:199], v[64:79]
    ds_read_b64_tr_b16 v[32:33], v18 offset:8192
    ds_read_b64_tr_b16 v[34:35], v18 offset:9216
    v_fma_f32 v148, v148, s67, -v30
    v_fma_f32 v149, v149, s67, -v30
    v_fma_f32 v150, v150, s67, -v30
    v_fma_f32 v151, v151, s67, -v30
    v_exp_f32 v144, v144
    v_exp_f32 v145, v145
    v_mfma_f32_32x32x16_bf16 v[80:95], v[52:55], v[196:199], v[80:95]
    ds_read_b64_tr_b16 v[36:37], v19 offset:8192
    ds_read_b64_tr_b16 v[38:39], v19 offset:9216
    v_exp_f32 v146, v146
    v_exp_f32 v147, v147
    v_exp_f32 v148, v148
    v_exp_f32 v149, v149
    v_exp_f32 v150, v150
    v_exp_f32 v151, v151
    v_mfma_f32_32x32x16_bf16 v[96:111], v[56:59], v[196:199], v[96:111]
    ds_read_b64_tr_b16 v[40:41], v20 offset:8192
    ds_read_b64_tr_b16 v[42:43], v20 offset:9216
    v_cvt_pk_bf16_f32 v200, v144, v145
    v_cvt_pk_bf16_f32 v201, v146, v147
    v_cvt_pk_bf16_f32 v202, v148, v149
    v_cvt_pk_bf16_f32 v203, v150, v151
    v_fma_f32 v152, v152, s67, -v29
    v_fma_f32 v153, v153, s67, -v29
    v_mfma_f32_32x32x16_bf16 v[112:127], v[60:63], v[196:199], v[112:127]
    ds_read_b64_tr_b16 v[44:45], v21 offset:8192
    ds_read_b64_tr_b16 v[46:47], v21 offset:9216
    v_permlane16_swap_b32 v200, v202
    v_permlane16_swap_b32 v201, v203
    v_fma_f32 v154, v154, s67, -v29
    v_fma_f32 v155, v155, s67, -v29
    v_mfma_f32_32x32x16_bf16 v[224:239], v[24:27], v[200:203], v[224:239]
    v_fma_f32 v156, v156, s67, -v30
    s_waitcnt lgkmcnt(0)
    v_mfma_f32_32x32x16_bf16 v[64:79], v[32:35], v[200:203], v[64:79]
    ds_read_b64_tr_b16 v[48:49], v18 offset:12288
    ds_read_b64_tr_b16 v[50:51], v18 offset:13312
    v_fma_f32 v157, v157, s67, -v30
    v_fma_f32 v158, v158, s67, -v30
    v_fma_f32 v159, v159, s67, -v30
    v_exp_f32 v152, v152
    v_exp_f32 v153, v153
    v_exp_f32 v154, v154
    v_mfma_f32_32x32x16_bf16 v[80:95], v[36:39], v[200:203], v[80:95]
    ds_read_b64_tr_b16 v[52:53], v19 offset:12288
    ds_read_b64_tr_b16 v[54:55], v19 offset:13312
    v_exp_f32 v155, v155
    v_exp_f32 v156, v156
    v_exp_f32 v157, v157
    v_exp_f32 v158, v158
    v_exp_f32 v159, v159
    v_cvt_pk_bf16_f32 v204, v152, v153
    v_mfma_f32_32x32x16_bf16 v[96:111], v[40:43], v[200:203], v[96:111]
    ds_read_b64_tr_b16 v[56:57], v20 offset:12288
    ds_read_b64_tr_b16 v[58:59], v20 offset:13312
    v_cvt_pk_bf16_f32 v205, v154, v155
    v_cvt_pk_bf16_f32 v206, v156, v157
    v_cvt_pk_bf16_f32 v207, v158, v159
    v_fma_f32 v160, v160, s67, -v29
    v_fma_f32 v161, v161, s67, -v29
    v_permlane16_swap_b32 v204, v206
    v_mfma_f32_32x32x16_bf16 v[112:127], v[44:47], v[200:203], v[112:127]
    ds_read_b64_tr_b16 v[60:61], v21 offset:12288
    ds_read_b64_tr_b16 v[62:63], v21 offset:13312
    v_permlane16_swap_b32 v205, v207
    v_fma_f32 v162, v162, s67, -v29
    v_fma_f32 v163, v163, s67, -v29
    v_mfma_f32_32x32x16_bf16 v[224:239], v[24:27], v[204:207], v[224:239]
    v_fma_f32 v164, v164, s67, -v30
    v_fma_f32 v165, v165, s67, -v30
    s_waitcnt lgkmcnt(0)
    v_mfma_f32_32x32x16_bf16 v[64:79], v[48:51], v[204:207], v[64:79]
    ds_read_b64_tr_b16 v[32:33], v18 offset:16384
    ds_read_b64_tr_b16 v[34:35], v18 offset:17408
    v_fma_f32 v166, v166, s67, -v30
    v_fma_f32 v167, v167, s67, -v30
    v_exp_f32 v160, v160
    v_exp_f32 v161, v161
    v_exp_f32 v162, v162
    v_exp_f32 v163, v163
    v_mfma_f32_32x32x16_bf16 v[80:95], v[52:55], v[204:207], v[80:95]
    ds_read_b64_tr_b16 v[36:37], v19 offset:16384
    ds_read_b64_tr_b16 v[38:39], v19 offset:17408
    v_exp_f32 v164, v164
    v_exp_f32 v165, v165
    v_exp_f32 v166, v166
    v_exp_f32 v167, v167
    v_cvt_pk_bf16_f32 v208, v160, v161
    v_cvt_pk_bf16_f32 v209, v162, v163
    v_mfma_f32_32x32x16_bf16 v[96:111], v[56:59], v[204:207], v[96:111]
    ds_read_b64_tr_b16 v[40:41], v20 offset:16384
    ds_read_b64_tr_b16 v[42:43], v20 offset:17408
    v_cvt_pk_bf16_f32 v210, v164, v165
    v_cvt_pk_bf16_f32 v211, v166, v167
    v_fma_f32 v168, v168, s67, -v29
    v_fma_f32 v169, v169, s67, -v29
    v_permlane16_swap_b32 v208, v210
    v_permlane16_swap_b32 v209, v211
    v_mfma_f32_32x32x16_bf16 v[112:127], v[60:63], v[204:207], v[112:127]
    ds_read_b64_tr_b16 v[44:45], v21 offset:16384
    ds_read_b64_tr_b16 v[46:47], v21 offset:17408
    v_fma_f32 v170, v170, s67, -v29
    v_fma_f32 v171, v171, s67, -v29
    v_mfma_f32_32x32x16_bf16 v[224:239], v[24:27], v[208:211], v[224:239]
    v_fma_f32 v172, v172, s67, -v30
    v_fma_f32 v173, v173, s67, -v30
    v_fma_f32 v174, v174, s67, -v30
    s_waitcnt lgkmcnt(0)
    v_mfma_f32_32x32x16_bf16 v[64:79], v[32:35], v[208:211], v[64:79]
    ds_read_b64_tr_b16 v[48:49], v18 offset:20480
    ds_read_b64_tr_b16 v[50:51], v18 offset:21504
    v_fma_f32 v175, v175, s67, -v30
    v_exp_f32 v168, v168
    v_exp_f32 v169, v169
    v_exp_f32 v170, v170
    v_exp_f32 v171, v171
    v_exp_f32 v172, v172
    v_mfma_f32_32x32x16_bf16 v[80:95], v[36:39], v[208:211], v[80:95]
    ds_read_b64_tr_b16 v[52:53], v19 offset:20480
    ds_read_b64_tr_b16 v[54:55], v19 offset:21504
    v_exp_f32 v173, v173
    v_exp_f32 v174, v174
    v_exp_f32 v175, v175
    v_cvt_pk_bf16_f32 v212, v168, v169
    v_cvt_pk_bf16_f32 v213, v170, v171
    v_cvt_pk_bf16_f32 v214, v172, v173
    v_mfma_f32_32x32x16_bf16 v[96:111], v[40:43], v[208:211], v[96:111]
    ds_read_b64_tr_b16 v[56:57], v20 offset:20480
    ds_read_b64_tr_b16 v[58:59], v20 offset:21504
    v_cvt_pk_bf16_f32 v215, v174, v175
    v_fma_f32 v176, v176, s67, -v29
    v_fma_f32 v177, v177, s67, -v29
    v_permlane16_swap_b32 v212, v214
    v_permlane16_swap_b32 v213, v215
    v_fma_f32 v178, v178, s67, -v29
    v_mfma_f32_32x32x16_bf16 v[112:127], v[44:47], v[208:211], v[112:127]
    ds_read_b64_tr_b16 v[60:61], v21 offset:20480
    ds_read_b64_tr_b16 v[62:63], v21 offset:21504
    v_fma_f32 v179, v179, s67, -v29
    v_mfma_f32_32x32x16_bf16 v[224:239], v[24:27], v[212:215], v[224:239]
    v_fma_f32 v180, v180, s67, -v30
    v_fma_f32 v181, v181, s67, -v30
    v_fma_f32 v182, v182, s67, -v30
    v_fma_f32 v183, v183, s67, -v30
    s_waitcnt lgkmcnt(0)
    v_mfma_f32_32x32x16_bf16 v[64:79], v[48:51], v[212:215], v[64:79]
    ds_read_b64_tr_b16 v[32:33], v18 offset:24576
    ds_read_b64_tr_b16 v[34:35], v18 offset:25600
    v_exp_f32 v176, v176
    v_exp_f32 v177, v177
    v_exp_f32 v178, v178
    v_exp_f32 v179, v179
    v_exp_f32 v180, v180
    v_exp_f32 v181, v181
    v_mfma_f32_32x32x16_bf16 v[80:95], v[52:55], v[212:215], v[80:95]
    ds_read_b64_tr_b16 v[36:37], v19 offset:24576
    ds_read_b64_tr_b16 v[38:39], v19 offset:25600
    v_exp_f32 v182, v182
    v_exp_f32 v183, v183
    v_cvt_pk_bf16_f32 v216, v176, v177
    v_cvt_pk_bf16_f32 v217, v178, v179
    v_cvt_pk_bf16_f32 v218, v180, v181
    v_cvt_pk_bf16_f32 v219, v182, v183
    v_mfma_f32_32x32x16_bf16 v[96:111], v[56:59], v[212:215], v[96:111]
    ds_read_b64_tr_b16 v[40:41], v20 offset:24576
    ds_read_b64_tr_b16 v[42:43], v20 offset:25600
    v_fma_f32 v184, v184, s67, -v29
    v_fma_f32 v185, v185, s67, -v29
    v_permlane16_swap_b32 v216, v218
    v_permlane16_swap_b32 v217, v219
    v_fma_f32 v186, v186, s67, -v29
    v_fma_f32 v187, v187, s67, -v29
    v_mfma_f32_32x32x16_bf16 v[112:127], v[60:63], v[212:215], v[112:127]
    ds_read_b64_tr_b16 v[44:45], v21 offset:24576
    ds_read_b64_tr_b16 v[46:47], v21 offset:25600
    v_mfma_f32_32x32x16_bf16 v[224:239], v[24:27], v[216:219], v[224:239]
    v_fma_f32 v188, v188, s67, -v30
    v_fma_f32 v189, v189, s67, -v30
    v_fma_f32 v190, v190, s67, -v30
    v_fma_f32 v191, v191, s67, -v30
    v_exp_f32 v184, v184
    s_waitcnt lgkmcnt(0)
    v_mfma_f32_32x32x16_bf16 v[64:79], v[32:35], v[216:219], v[64:79]
    ds_read_b64_tr_b16 v[48:49], v18 offset:28672
    ds_read_b64_tr_b16 v[50:51], v18 offset:29696
    v_exp_f32 v185, v185
    v_exp_f32 v186, v186
    v_exp_f32 v187, v187
    v_exp_f32 v188, v188
    v_exp_f32 v189, v189
    v_exp_f32 v190, v190
    v_mfma_f32_32x32x16_bf16 v[80:95], v[36:39], v[216:219], v[80:95]
    ds_read_b64_tr_b16 v[52:53], v19 offset:28672
    ds_read_b64_tr_b16 v[54:55], v19 offset:29696
    v_exp_f32 v191, v191
    v_cvt_pk_bf16_f32 v220, v184, v185
    v_cvt_pk_bf16_f32 v221, v186, v187
    v_cvt_pk_bf16_f32 v222, v188, v189
    v_cvt_pk_bf16_f32 v223, v190, v191
    s_nop 0
    v_permlane16_swap_b32 v220, v222
    v_mfma_f32_32x32x16_bf16 v[96:111], v[40:43], v[216:219], v[96:111]
    ds_read_b64_tr_b16 v[56:57], v20 offset:28672
    ds_read_b64_tr_b16 v[58:59], v20 offset:29696
    v_permlane16_swap_b32 v221, v223
    s_nop 1
    v_mfma_f32_32x32x16_bf16 v[224:239], v[24:27], v[220:223], v[224:239]
    v_mfma_f32_32x32x16_bf16 v[112:127], v[44:47], v[216:219], v[112:127]
    ds_read_b64_tr_b16 v[60:61], v21 offset:28672
    ds_read_b64_tr_b16 v[62:63], v21 offset:29696
    s_waitcnt lgkmcnt(0)
    v_mfma_f32_32x32x16_bf16 v[64:79], v[48:51], v[220:223], v[64:79]
    v_mfma_f32_32x32x16_bf16 v[80:95], v[52:55], v[220:223], v[80:95]
    v_mfma_f32_32x32x16_bf16 v[96:111], v[56:59], v[220:223], v[96:111]
    s_nop 4
    v_rcp_f32 v31, v224
    v_mfma_f32_32x32x16_bf16 v[112:127], v[60:63], v[220:223], v[112:127]
    v_mov_b32 v30, v31
    s_nop 1
    v_pk_mul_f32 v[64:65], v[64:65], v[30:31]
    v_pk_mul_f32 v[66:67], v[66:67], v[30:31]
    v_pk_mul_f32 v[68:69], v[68:69], v[30:31]
    v_pk_mul_f32 v[70:71], v[70:71], v[30:31]
    v_cvt_pk_bf16_f32 v192, v64, v65
    v_cvt_pk_bf16_f32 v193, v66, v67
    v_cvt_pk_bf16_f32 v194, v68, v69
    v_cvt_pk_bf16_f32 v195, v70, v71
    v_pk_mul_f32 v[72:73], v[72:73], v[30:31]
    v_pk_mul_f32 v[74:75], v[74:75], v[30:31]
    v_pk_mul_f32 v[76:77], v[76:77], v[30:31]
    v_pk_mul_f32 v[78:79], v[78:79], v[30:31]
    v_cvt_pk_bf16_f32 v196, v72, v73
    v_cvt_pk_bf16_f32 v197, v74, v75
    v_cvt_pk_bf16_f32 v198, v76, v77
    v_cvt_pk_bf16_f32 v199, v78, v79
    v_permlane16_swap_b32 v192, v196
    v_permlane16_swap_b32 v193, v197
    v_permlane16_swap_b32 v194, v198
    v_permlane16_swap_b32 v195, v199
    buffer_store_dwordx4 v[192:195], v23, s[60:63], s9 offen offset:0 sc1
    buffer_store_dwordx4 v[196:199], v23, s[60:63], s9 offen offset:1024 sc1
    v_pk_mul_f32 v[80:81], v[80:81], v[30:31]
    v_pk_mul_f32 v[82:83], v[82:83], v[30:31]
    v_pk_mul_f32 v[84:85], v[84:85], v[30:31]
    v_pk_mul_f32 v[86:87], v[86:87], v[30:31]
    v_cvt_pk_bf16_f32 v200, v80, v81
    v_cvt_pk_bf16_f32 v201, v82, v83
    v_cvt_pk_bf16_f32 v202, v84, v85
    v_cvt_pk_bf16_f32 v203, v86, v87
    v_pk_mul_f32 v[88:89], v[88:89], v[30:31]
    v_pk_mul_f32 v[90:91], v[90:91], v[30:31]
    v_pk_mul_f32 v[92:93], v[92:93], v[30:31]
    v_pk_mul_f32 v[94:95], v[94:95], v[30:31]
    v_cvt_pk_bf16_f32 v204, v88, v89
    v_cvt_pk_bf16_f32 v205, v90, v91
    v_cvt_pk_bf16_f32 v206, v92, v93
    v_cvt_pk_bf16_f32 v207, v94, v95
    v_permlane16_swap_b32 v200, v204
    v_permlane16_swap_b32 v201, v205
    v_permlane16_swap_b32 v202, v206
    v_permlane16_swap_b32 v203, v207
    buffer_store_dwordx4 v[200:203], v23, s[60:63], s9 offen offset:2048 sc1
    buffer_store_dwordx4 v[204:207], v23, s[60:63], s9 offen offset:3072 sc1
    v_pk_mul_f32 v[96:97], v[96:97], v[30:31]
    v_pk_mul_f32 v[98:99], v[98:99], v[30:31]
    v_pk_mul_f32 v[100:101], v[100:101], v[30:31]
    v_pk_mul_f32 v[102:103], v[102:103], v[30:31]
    v_cvt_pk_bf16_f32 v208, v96, v97
    v_cvt_pk_bf16_f32 v209, v98, v99
    v_cvt_pk_bf16_f32 v210, v100, v101
    v_cvt_pk_bf16_f32 v211, v102, v103
    v_pk_mul_f32 v[104:105], v[104:105], v[30:31]
    v_pk_mul_f32 v[106:107], v[106:107], v[30:31]
    v_pk_mul_f32 v[108:109], v[108:109], v[30:31]
    v_pk_mul_f32 v[110:111], v[110:111], v[30:31]
    v_cvt_pk_bf16_f32 v212, v104, v105
    v_cvt_pk_bf16_f32 v213, v106, v107
    v_cvt_pk_bf16_f32 v214, v108, v109
    v_cvt_pk_bf16_f32 v215, v110, v111
    v_permlane16_swap_b32 v208, v212
    v_permlane16_swap_b32 v209, v213
    v_permlane16_swap_b32 v210, v214
    v_permlane16_swap_b32 v211, v215
    buffer_store_dwordx4 v[208:211], v23, s[60:63], s10 offen offset:0 sc1
    buffer_store_dwordx4 v[212:215], v23, s[60:63], s10 offen offset:1024 sc1
    v_pk_mul_f32 v[112:113], v[112:113], v[30:31]
    v_pk_mul_f32 v[114:115], v[114:115], v[30:31]
    v_pk_mul_f32 v[116:117], v[116:117], v[30:31]
    v_pk_mul_f32 v[118:119], v[118:119], v[30:31]
    v_cvt_pk_bf16_f32 v216, v112, v113
    v_cvt_pk_bf16_f32 v217, v114, v115
    v_cvt_pk_bf16_f32 v218, v116, v117
    v_cvt_pk_bf16_f32 v219, v118, v119
    v_pk_mul_f32 v[120:121], v[120:121], v[30:31]
    v_pk_mul_f32 v[122:123], v[122:123], v[30:31]
    v_pk_mul_f32 v[124:125], v[124:125], v[30:31]
    v_pk_mul_f32 v[126:127], v[126:127], v[30:31]
    v_cvt_pk_bf16_f32 v220, v120, v121
    v_cvt_pk_bf16_f32 v221, v122, v123
    v_cvt_pk_bf16_f32 v222, v124, v125
    v_cvt_pk_bf16_f32 v223, v126, v127
    v_permlane16_swap_b32 v216, v220
    v_permlane16_swap_b32 v217, v221
    v_permlane16_swap_b32 v218, v222
    v_permlane16_swap_b32 v219, v223
    buffer_store_dwordx4 v[216:219], v23, s[60:63], s10 offen offset:2048 sc1
    buffer_store_dwordx4 v[220:223], v23, s[60:63], s10 offen offset:3072 sc1
    s_barrier
    v_add_u32 v244, s32, v240
    v_add_u32 v245, s32, v241
    v_add_u32 v246, s32, v242
    v_add_u32 v247, s32, v243
    ds_read_b64_tr_b16 v[32:33], v244 offset:0
    ds_read_b64_tr_b16 v[34:35], v244 offset:1024
    ds_read_b64_tr_b16 v[36:37], v245 offset:0
    ds_read_b64_tr_b16 v[38:39], v245 offset:1024
    ds_read_b64_tr_b16 v[40:41], v246 offset:0
    ds_read_b64_tr_b16 v[42:43], v246 offset:1024
    ds_read_b64_tr_b16 v[44:45], v247 offset:0
    ds_read_b64_tr_b16 v[46:47], v247 offset:1024
    s_waitcnt lgkmcnt(4)
    v_mfma_f32_16x16x32_bf16 v[128:131], v[32:35], v[192:195], 0
    ds_read_b64_tr_b16 v[48:49], v244 offset:4096
    v_mfma_f32_16x16x32_bf16 v[132:135], v[32:35], v[196:199], 0
    ds_read_b64_tr_b16 v[50:51], v244 offset:5120
    v_mfma_f32_16x16x32_bf16 v[136:139], v[36:39], v[192:195], 0
    ds_read_b64_tr_b16 v[52:53], v245 offset:4096
    v_mfma_f32_16x16x32_bf16 v[140:143], v[36:39], v[196:199], 0
    ds_read_b64_tr_b16 v[54:55], v245 offset:5120
    s_waitcnt lgkmcnt(4)
    v_mfma_f32_16x16x32_bf16 v[144:147], v[40:43], v[192:195], 0
    ds_read_b64_tr_b16 v[56:57], v246 offset:4096
    v_mfma_f32_16x16x32_bf16 v[148:151], v[40:43], v[196:199], 0
    ds_read_b64_tr_b16 v[58:59], v246 offset:5120
    v_mfma_f32_16x16x32_bf16 v[152:155], v[44:47], v[192:195], 0
    ds_read_b64_tr_b16 v[60:61], v247 offset:4096
    v_mfma_f32_16x16x32_bf16 v[156:159], v[44:47], v[196:199], 0
    ds_read_b64_tr_b16 v[62:63], v247 offset:5120
    s_waitcnt lgkmcnt(4)
    v_mfma_f32_16x16x32_bf16 v[128:131], v[48:51], v[200:203], v[128:131]
    ds_read_b64_tr_b16 v[32:33], v244 offset:8192
    v_mfma_f32_16x16x32_bf16 v[132:135], v[48:51], v[204:207], v[132:135]
    ds_read_b64_tr_b16 v[34:35], v244 offset:9216
    v_mfma_f32_16x16x32_bf16 v[136:139], v[52:55], v[200:203], v[136:139]
    ds_read_b64_tr_b16 v[36:37], v245 offset:8192
    v_mfma_f32_16x16x32_bf16 v[140:143], v[52:55], v[204:207], v[140:143]
    ds_read_b64_tr_b16 v[38:39], v245 offset:9216
    s_waitcnt lgkmcnt(4)
    v_mfma_f32_16x16x32_bf16 v[144:147], v[56:59], v[200:203], v[144:147]
    ds_read_b64_tr_b16 v[40:41], v246 offset:8192
    v_mfma_f32_16x16x32_bf16 v[148:151], v[56:59], v[204:207], v[148:151]
    ds_read_b64_tr_b16 v[42:43], v246 offset:9216
    v_mfma_f32_16x16x32_bf16 v[152:155], v[60:63], v[200:203], v[152:155]
    ds_read_b64_tr_b16 v[44:45], v247 offset:8192
    v_mfma_f32_16x16x32_bf16 v[156:159], v[60:63], v[204:207], v[156:159]
    ds_read_b64_tr_b16 v[46:47], v247 offset:9216
    s_waitcnt lgkmcnt(4)
    v_mfma_f32_16x16x32_bf16 v[128:131], v[32:35], v[208:211], v[128:131]
    ds_read_b64_tr_b16 v[48:49], v244 offset:12288
    v_mfma_f32_16x16x32_bf16 v[132:135], v[32:35], v[212:215], v[132:135]
    ds_read_b64_tr_b16 v[50:51], v244 offset:13312
    v_mfma_f32_16x16x32_bf16 v[136:139], v[36:39], v[208:211], v[136:139]
    ds_read_b64_tr_b16 v[52:53], v245 offset:12288
    v_mfma_f32_16x16x32_bf16 v[140:143], v[36:39], v[212:215], v[140:143]
    ds_read_b64_tr_b16 v[54:55], v245 offset:13312
    s_waitcnt lgkmcnt(4)
    v_mfma_f32_16x16x32_bf16 v[144:147], v[40:43], v[208:211], v[144:147]
    ds_read_b64_tr_b16 v[56:57], v246 offset:12288
    v_mfma_f32_16x16x32_bf16 v[148:151], v[40:43], v[212:215], v[148:151]
    ds_read_b64_tr_b16 v[58:59], v246 offset:13312
    v_mfma_f32_16x16x32_bf16 v[152:155], v[44:47], v[208:211], v[152:155]
    ds_read_b64_tr_b16 v[60:61], v247 offset:12288
    v_mfma_f32_16x16x32_bf16 v[156:159], v[44:47], v[212:215], v[156:159]
    ds_read_b64_tr_b16 v[62:63], v247 offset:13312
    v_add_u32 v248, s33, v240
    v_add_u32 v249, s33, v241
    v_add_u32 v250, s33, v242
    v_add_u32 v251, s33, v243
    s_waitcnt lgkmcnt(4)
    v_mfma_f32_16x16x32_bf16 v[128:131], v[48:51], v[216:219], v[128:131]
    ds_read_b64_tr_b16 v[32:33], v248 offset:0
    v_mfma_f32_16x16x32_bf16 v[132:135], v[48:51], v[220:223], v[132:135]
    ds_read_b64_tr_b16 v[34:35], v248 offset:1024
    v_mfma_f32_16x16x32_bf16 v[136:139], v[52:55], v[216:219], v[136:139]
    ds_read_b64_tr_b16 v[36:37], v249 offset:0
    v_mfma_f32_16x16x32_bf16 v[140:143], v[52:55], v[220:223], v[140:143]
    ds_read_b64_tr_b16 v[38:39], v249 offset:1024
    s_waitcnt lgkmcnt(4)
    v_mfma_f32_16x16x32_bf16 v[144:147], v[56:59], v[216:219], v[144:147]
    ds_read_b64_tr_b16 v[40:41], v250 offset:0
    v_mfma_f32_16x16x32_bf16 v[148:151], v[56:59], v[220:223], v[148:151]
    ds_read_b64_tr_b16 v[42:43], v250 offset:1024
    v_mfma_f32_16x16x32_bf16 v[152:155], v[60:63], v[216:219], v[152:155]
    ds_read_b64_tr_b16 v[44:45], v251 offset:0
    v_mfma_f32_16x16x32_bf16 v[156:159], v[60:63], v[220:223], v[156:159]
    ds_read_b64_tr_b16 v[46:47], v251 offset:1024
    s_waitcnt vmcnt(0)
    s_barrier
    s_cmp_lg_u32 s3, 0
    s_cbranch_scc1 L_p1_skip
    v_cmp_ne_u32 vcc, v6, v24
    s_cbranch_vccz L_hs_ok
    s_lshl_b32 s6, s5, 5
    s_mov_b32 s7, 262144
L_hs:
    buffer_load_dword v6, v28, s[56:59], s6 offen sc1
    s_waitcnt vmcnt(0)
    v_cmp_ne_u32 vcc, v6, v24
    s_cbranch_vccz L_hs_ok
    s_sleep 1
    s_sub_u32 s7, s7, 1
    s_cmp_lg_u32 s7, 0
    s_cbranch_scc1 L_hs
    s_endpgm
L_hs_ok:
    v_lshlrev_b32 v2, 9, v1
    s_mov_b64 exec, 15
    buffer_store_dwordx4 v[24:27], v23, s[60:63], s42 offen sc1
    s_mov_b32 exec_lo, s44
    s_mov_b32 s7, 262144
L_p1:
    buffer_load_dword v4, v2, s[60:63], s43 offen sc1
    s_waitcnt vmcnt(0)
    v_cmp_ne_u32 vcc, v4, v24
    s_cbranch_vccz L_p1_ok
    s_sleep 1
    s_sub_u32 s7, s7, 1
    s_cmp_lg_u32 s7, 0
    s_cbranch_scc1 L_p1
    s_endpgm
L_p1_ok:
    s_mov_b64 exec, -1
L_p1_skip:
    s_barrier
    buffer_load_dwordx4 v[64:67], v23, s[60:63], s16 offen offset:0 sc1
    buffer_load_dwordx4 v[68:71], v23, s[60:63], s16 offen offset:1024 sc1
    buffer_load_dwordx4 v[72:75], v23, s[60:63], s16 offen offset:2048 sc1
    buffer_load_dwordx4 v[76:79], v23, s[60:63], s16 offen offset:3072 sc1
    buffer_load_dwordx4 v[80:83], v23, s[60:63], s17 offen offset:0 sc1
    buffer_load_dwordx4 v[84:87], v23, s[60:63], s17 offen offset:1024 sc1
    buffer_load_dwordx4 v[88:91], v23, s[60:63], s17 offen offset:2048 sc1
    buffer_load_dwordx4 v[92:95], v23, s[60:63], s17 offen offset:3072 sc1
    buffer_load_dwordx4 v[96:99], v23, s[60:63], s18 offen offset:0 sc1
    buffer_load_dwordx4 v[100:103], v23, s[60:63], s18 offen offset:1024 sc1
    buffer_load_dwordx4 v[104:107], v23, s[60:63], s18 offen offset:2048 sc1
    buffer_load_dwordx4 v[108:111], v23, s[60:63], s18 offen offset:3072 sc1
    buffer_load_dwordx4 v[112:115], v23, s[60:63], s19 offen offset:0 sc1
    buffer_load_dwordx4 v[116:119], v23, s[60:63], s19 offen offset:1024 sc1
    buffer_load_dwordx4 v[120:123], v23, s[60:63], s19 offen offset:2048 sc1
    buffer_load_dwordx4 v[124:127], v23, s[60:63], s19 offen offset:3072 sc1
    s_waitcnt vmcnt(14) lgkmcnt(4)
    v_mfma_f32_16x16x32_bf16 v[128:131], v[32:35], v[64:67], v[128:131]
    ds_read_b64_tr_b16 v[48:49], v248 offset:4096
    v_mfma_f32_16x16x32_bf16 v[132:135], v[32:35], v[68:71], v[132:135]
    ds_read_b64_tr_b16 v[50:51], v248 offset:5120
    v_mfma_f32_16x16x32_bf16 v[136:139], v[36:39], v[64:67], v[136:139]
    ds_read_b64_tr_b16 v[52:53], v249 offset:4096
    v_mfma_f32_16x16x32_bf16 v[140:143], v[36:39], v[68:71], v[140:143]
    ds_read_b64_tr_b16 v[54:55], v249 offset:5120
    buffer_load_dwordx4 v[160:163], v23, s[60:63], s20 offen offset:0 sc1
    s_waitcnt lgkmcnt(4)
    v_mfma_f32_16x16x32_bf16 v[144:147], v[40:43], v[64:67], v[144:147]
    ds_read_b64_tr_b16 v[56:57], v250 offset:4096
    v_mfma_f32_16x16x32_bf16 v[148:151], v[40:43], v[68:71], v[148:151]
    ds_read_b64_tr_b16 v[58:59], v250 offset:5120
    v_mfma_f32_16x16x32_bf16 v[152:155], v[44:47], v[64:67], v[152:155]
    ds_read_b64_tr_b16 v[60:61], v251 offset:4096
    v_mfma_f32_16x16x32_bf16 v[156:159], v[44:47], v[68:71], v[156:159]
    ds_read_b64_tr_b16 v[62:63], v251 offset:5120
    buffer_load_dwordx4 v[164:167], v23, s[60:63], s20 offen offset:1024 sc1
    s_waitcnt vmcnt(14) lgkmcnt(4)
    v_mfma_f32_16x16x32_bf16 v[128:131], v[48:51], v[72:75], v[128:131]
    ds_read_b64_tr_b16 v[32:33], v248 offset:8192
    v_mfma_f32_16x16x32_bf16 v[132:135], v[48:51], v[76:79], v[132:135]
    ds_read_b64_tr_b16 v[34:35], v248 offset:9216
    v_mfma_f32_16x16x32_bf16 v[136:139], v[52:55], v[72:75], v[136:139]
    ds_read_b64_tr_b16 v[36:37], v249 offset:8192
    v_mfma_f32_16x16x32_bf16 v[140:143], v[52:55], v[76:79], v[140:143]
    ds_read_b64_tr_b16 v[38:39], v249 offset:9216
    buffer_load_dwordx4 v[168:171], v23, s[60:63], s20 offen offset:2048 sc1
    s_waitcnt lgkmcnt(4)
    v_mfma_f32_16x16x32_bf16 v[144:147], v[56:59], v[72:75], v[144:147]
    ds_read_b64_tr_b16 v[40:41], v250 offset:8192
    v_mfma_f32_16x16x32_bf16 v[148:151], v[56:59], v[76:79], v[148:151]
    ds_read_b64_tr_b16 v[42:43], v250 offset:9216
    v_mfma_f32_16x16x32_bf16 v[152:155], v[60:63], v[72:75], v[152:155]
    ds_read_b64_tr_b16 v[44:45], v251 offset:8192
    v_mfma_f32_16x16x32_bf16 v[156:159], v[60:63], v[76:79], v[156:159]
    ds_read_b64_tr_b16 v[46:47], v251 offset:9216
    buffer_load_dwordx4 v[172:175], v23, s[60:63], s20 offen offset:3072 sc1
    s_waitcnt vmcnt(14) lgkmcnt(4)
    v_mfma_f32_16x16x32_bf16 v[128:131], v[32:35], v[80:83], v[128:131]
    ds_read_b64_tr_b16 v[48:49], v248 offset:12288
    v_mfma_f32_16x16x32_bf16 v[132:135], v[32:35], v[84:87], v[132:135]
    ds_read_b64_tr_b16 v[50:51], v248 offset:13312
    v_mfma_f32_16x16x32_bf16 v[136:139], v[36:39], v[80:83], v[136:139]
    ds_read_b64_tr_b16 v[52:53], v249 offset:12288
    v_mfma_f32_16x16x32_bf16 v[140:143], v[36:39], v[84:87], v[140:143]
    ds_read_b64_tr_b16 v[54:55], v249 offset:13312
    buffer_load_dwordx4 v[176:179], v23, s[60:63], s21 offen offset:0 sc1
    s_waitcnt lgkmcnt(4)
    v_mfma_f32_16x16x32_bf16 v[144:147], v[40:43], v[80:83], v[144:147]
    ds_read_b64_tr_b16 v[56:57], v250 offset:12288
    v_mfma_f32_16x16x32_bf16 v[148:151], v[40:43], v[84:87], v[148:151]
    ds_read_b64_tr_b16 v[58:59], v250 offset:13312
    v_mfma_f32_16x16x32_bf16 v[152:155], v[44:47], v[80:83], v[152:155]
    ds_read_b64_tr_b16 v[60:61], v251 offset:12288
    v_mfma_f32_16x16x32_bf16 v[156:159], v[44:47], v[84:87], v[156:159]
    ds_read_b64_tr_b16 v[62:63], v251 offset:13312
    buffer_load_dwordx4 v[180:183], v23, s[60:63], s21 offen offset:1024 sc1
    v_add_u32 v244, s34, v240
    v_add_u32 v245, s34, v241
    v_add_u32 v246, s34, v242
    v_add_u32 v247, s34, v243
    s_waitcnt vmcnt(14) lgkmcnt(4)
    v_mfma_f32_16x16x32_bf16 v[128:131], v[48:51], v[88:91], v[128:131]
    ds_read_b64_tr_b16 v[32:33], v244 offset:0
    v_mfma_f32_16x16x32_bf16 v[132:135], v[48:51], v[92:95], v[132:135]
    ds_read_b64_tr_b16 v[34:35], v244 offset:1024
    v_mfma_f32_16x16x32_bf16 v[136:139], v[52:55], v[88:91], v[136:139]
    ds_read_b64_tr_b16 v[36:37], v245 offset:0
    v_mfma_f32_16x16x32_bf16 v[140:143], v[52:55], v[92:95], v[140:143]
    ds_read_b64_tr_b16 v[38:39], v245 offset:1024
    buffer_load_dwordx4 v[184:187], v23, s[60:63], s21 offen offset:2048 sc1
    s_waitcnt lgkmcnt(4)
    v_mfma_f32_16x16x32_bf16 v[144:147], v[56:59], v[88:91], v[144:147]
    ds_read_b64_tr_b16 v[40:41], v246 offset:0
    v_mfma_f32_16x16x32_bf16 v[148:151], v[56:59], v[92:95], v[148:151]
    ds_read_b64_tr_b16 v[42:43], v246 offset:1024
    v_mfma_f32_16x16x32_bf16 v[152:155], v[60:63], v[88:91], v[152:155]
    ds_read_b64_tr_b16 v[44:45], v247 offset:0
    v_mfma_f32_16x16x32_bf16 v[156:159], v[60:63], v[92:95], v[156:159]
    ds_read_b64_tr_b16 v[46:47], v247 offset:1024
    buffer_load_dwordx4 v[188:191], v23, s[60:63], s21 offen offset:3072 sc1
    s_waitcnt vmcnt(14) lgkmcnt(4)
    v_mfma_f32_16x16x32_bf16 v[128:131], v[32:35], v[96:99], v[128:131]
    ds_read_b64_tr_b16 v[48:49], v244 offset:4096
    v_mfma_f32_16x16x32_bf16 v[132:135], v[32:35], v[100:103], v[132:135]
    ds_read_b64_tr_b16 v[50:51], v244 offset:5120
    v_mfma_f32_16x16x32_bf16 v[136:139], v[36:39], v[96:99], v[136:139]
    ds_read_b64_tr_b16 v[52:53], v245 offset:4096
    v_mfma_f32_16x16x32_bf16 v[140:143], v[36:39], v[100:103], v[140:143]
    ds_read_b64_tr_b16 v[54:55], v245 offset:5120
    buffer_load_dwordx4 v[64:67], v23, s[60:63], s22 offen offset:0 sc1
    s_waitcnt lgkmcnt(4)
    v_mfma_f32_16x16x32_bf16 v[144:147], v[40:43], v[96:99], v[144:147]
    ds_read_b64_tr_b16 v[56:57], v246 offset:4096
    v_mfma_f32_16x16x32_bf16 v[148:151], v[40:43], v[100:103], v[148:151]
    ds_read_b64_tr_b16 v[58:59], v246 offset:5120
    v_mfma_f32_16x16x32_bf16 v[152:155], v[44:47], v[96:99], v[152:155]
    ds_read_b64_tr_b16 v[60:61], v247 offset:4096
    v_mfma_f32_16x16x32_bf16 v[156:159], v[44:47], v[100:103], v[156:159]
    ds_read_b64_tr_b16 v[62:63], v247 offset:5120
    buffer_load_dwordx4 v[68:71], v23, s[60:63], s22 offen offset:1024 sc1
    s_waitcnt vmcnt(14) lgkmcnt(4)
    v_mfma_f32_16x16x32_bf16 v[128:131], v[48:51], v[104:107], v[128:131]
    ds_read_b64_tr_b16 v[32:33], v244 offset:8192
    v_mfma_f32_16x16x32_bf16 v[132:135], v[48:51], v[108:111], v[132:135]
    ds_read_b64_tr_b16 v[34:35], v244 offset:9216
    v_mfma_f32_16x16x32_bf16 v[136:139], v[52:55], v[104:107], v[136:139]
    ds_read_b64_tr_b16 v[36:37], v245 offset:8192
    v_mfma_f32_16x16x32_bf16 v[140:143], v[52:55], v[108:111], v[140:143]
    ds_read_b64_tr_b16 v[38:39], v245 offset:9216
    buffer_load_dwordx4 v[72:75], v23, s[60:63], s22 offen offset:2048 sc1
    s_waitcnt lgkmcnt(4)
    v_mfma_f32_16x16x32_bf16 v[144:147], v[56:59], v[104:107], v[144:147]
    ds_read_b64_tr_b16 v[40:41], v246 offset:8192
    v_mfma_f32_16x16x32_bf16 v[148:151], v[56:59], v[108:111], v[148:151]
    ds_read_b64_tr_b16 v[42:43], v246 offset:9216
    v_mfma_f32_16x16x32_bf16 v[152:155], v[60:63], v[104:107], v[152:155]
    ds_read_b64_tr_b16 v[44:45], v247 offset:8192
    v_mfma_f32_16x16x32_bf16 v[156:159], v[60:63], v[108:111], v[156:159]
    ds_read_b64_tr_b16 v[46:47], v247 offset:9216
    buffer_load_dwordx4 v[76:79], v23, s[60:63], s22 offen offset:3072 sc1
    s_waitcnt vmcnt(14) lgkmcnt(4)
    v_mfma_f32_16x16x32_bf16 v[128:131], v[32:35], v[112:115], v[128:131]
    ds_read_b64_tr_b16 v[48:49], v244 offset:12288
    v_mfma_f32_16x16x32_bf16 v[132:135], v[32:35], v[116:119], v[132:135]
    ds_read_b64_tr_b16 v[50:51], v244 offset:13312
    v_mfma_f32_16x16x32_bf16 v[136:139], v[36:39], v[112:115], v[136:139]
    ds_read_b64_tr_b16 v[52:53], v245 offset:12288
    v_mfma_f32_16x16x32_bf16 v[140:143], v[36:39], v[116:119], v[140:143]
    ds_read_b64_tr_b16 v[54:55], v245 offset:13312
    buffer_load_dwordx4 v[80:83], v23, s[60:63], s23 offen offset:0 sc1
    s_waitcnt lgkmcnt(4)
    v_mfma_f32_16x16x32_bf16 v[144:147], v[40:43], v[112:115], v[144:147]
    ds_read_b64_tr_b16 v[56:57], v246 offset:12288
    v_mfma_f32_16x16x32_bf16 v[148:151], v[40:43], v[116:119], v[148:151]
    ds_read_b64_tr_b16 v[58:59], v246 offset:13312
    v_mfma_f32_16x16x32_bf16 v[152:155], v[44:47], v[112:115], v[152:155]
    ds_read_b64_tr_b16 v[60:61], v247 offset:12288
    v_mfma_f32_16x16x32_bf16 v[156:159], v[44:47], v[116:119], v[156:159]
    ds_read_b64_tr_b16 v[62:63], v247 offset:13312
    buffer_load_dwordx4 v[84:87], v23, s[60:63], s23 offen offset:1024 sc1
    v_add_u32 v248, s35, v240
    v_add_u32 v249, s35, v241
    v_add_u32 v250, s35, v242
    v_add_u32 v251, s35, v243
    s_waitcnt vmcnt(14) lgkmcnt(4)
    v_mfma_f32_16x16x32_bf16 v[128:131], v[48:51], v[120:123], v[128:131]
    ds_read_b64_tr_b16 v[32:33], v248 offset:0
    v_mfma_f32_16x16x32_bf16 v[132:135], v[48:51], v[124:127], v[132:135]
    ds_read_b64_tr_b16 v[34:35], v248 offset:1024
    v_mfma_f32_16x16x32_bf16 v[136:139], v[52:55], v[120:123], v[136:139]
    ds_read_b64_tr_b16 v[36:37], v249 offset:0
    v_mfma_f32_16x16x32_bf16 v[140:143], v[52:55], v[124:127], v[140:143]
    ds_read_b64_tr_b16 v[38:39], v249 offset:1024
    buffer_load_dwordx4 v[88:91], v23, s[60:63], s23 offen offset:2048 sc1
    s_waitcnt lgkmcnt(4)
    v_mfma_f32_16x16x32_bf16 v[144:147], v[56:59], v[120:123], v[144:147]
    ds_read_b64_tr_b16 v[40:41], v250 offset:0
    v_mfma_f32_16x16x32_bf16 v[148:151], v[56:59], v[124:127], v[148:151]
    ds_read_b64_tr_b16 v[42:43], v250 offset:1024
    v_mfma_f32_16x16x32_bf16 v[152:155], v[60:63], v[120:123], v[152:155]
    ds_read_b64_tr_b16 v[44:45], v251 offset:0
    v_mfma_f32_16x16x32_bf16 v[156:159], v[60:63], v[124:127], v[156:159]
    ds_read_b64_tr_b16 v[46:47], v251 offset:1024
    buffer_load_dwordx4 v[92:95], v23, s[60:63], s23 offen offset:3072 sc1
    s_waitcnt vmcnt(14) lgkmcnt(4)
    v_mfma_f32_16x16x32_bf16 v[128:131], v[32:35], v[160:163], v[128:131]
    ds_read_b64_tr_b16 v[48:49], v248 offset:4096
    v_mfma_f32_16x16x32_bf16 v[132:135], v[32:35], v[164:167], v[132:135]
    ds_read_b64_tr_b16 v[50:51], v248 offset:5120
    v_mfma_f32_16x16x32_bf16 v[136:139], v[36:39], v[160:163], v[136:139]
    ds_read_b64_tr_b16 v[52:53], v249 offset:4096
    v_mfma_f32_16x16x32_bf16 v[140:143], v[36:39], v[164:167], v[140:143]
    ds_read_b64_tr_b16 v[54:55], v249 offset:5120
    buffer_load_dwordx4 v[96:99], v23, s[60:63], s24 offen offset:0 sc1
    s_waitcnt lgkmcnt(4)
    v_mfma_f32_16x16x32_bf16 v[144:147], v[40:43], v[160:163], v[144:147]
    ds_read_b64_tr_b16 v[56:57], v250 offset:4096
    v_mfma_f32_16x16x32_bf16 v[148:151], v[40:43], v[164:167], v[148:151]
    ds_read_b64_tr_b16 v[58:59], v250 offset:5120
    v_mfma_f32_16x16x32_bf16 v[152:155], v[44:47], v[160:163], v[152:155]
    ds_read_b64_tr_b16 v[60:61], v251 offset:4096
    v_mfma_f32_16x16x32_bf16 v[156:159], v[44:47], v[164:167], v[156:159]
    ds_read_b64_tr_b16 v[62:63], v251 offset:5120
    buffer_load_dwordx4 v[100:103], v23, s[60:63], s24 offen offset:1024 sc1
    s_waitcnt vmcnt(14) lgkmcnt(4)
    v_mfma_f32_16x16x32_bf16 v[128:131], v[48:51], v[168:171], v[128:131]
    ds_read_b64_tr_b16 v[32:33], v248 offset:8192
    v_mfma_f32_16x16x32_bf16 v[132:135], v[48:51], v[172:175], v[132:135]
    ds_read_b64_tr_b16 v[34:35], v248 offset:9216
    v_mfma_f32_16x16x32_bf16 v[136:139], v[52:55], v[168:171], v[136:139]
    ds_read_b64_tr_b16 v[36:37], v249 offset:8192
    v_mfma_f32_16x16x32_bf16 v[140:143], v[52:55], v[172:175], v[140:143]
    ds_read_b64_tr_b16 v[38:39], v249 offset:9216
    buffer_load_dwordx4 v[104:107], v23, s[60:63], s24 offen offset:2048 sc1
    s_waitcnt lgkmcnt(4)
    v_mfma_f32_16x16x32_bf16 v[144:147], v[56:59], v[168:171], v[144:147]
    ds_read_b64_tr_b16 v[40:41], v250 offset:8192
    v_mfma_f32_16x16x32_bf16 v[148:151], v[56:59], v[172:175], v[148:151]
    ds_read_b64_tr_b16 v[42:43], v250 offset:9216
    v_mfma_f32_16x16x32_bf16 v[152:155], v[60:63], v[168:171], v[152:155]
    ds_read_b64_tr_b16 v[44:45], v251 offset:8192
    v_mfma_f32_16x16x32_bf16 v[156:159], v[60:63], v[172:175], v[156:159]
    ds_read_b64_tr_b16 v[46:47], v251 offset:9216
    buffer_load_dwordx4 v[108:111], v23, s[60:63], s24 offen offset:3072 sc1
    s_waitcnt vmcnt(14) lgkmcnt(4)
    v_mfma_f32_16x16x32_bf16 v[128:131], v[32:35], v[176:179], v[128:131]
    ds_read_b64_tr_b16 v[48:49], v248 offset:12288
    v_mfma_f32_16x16x32_bf16 v[132:135], v[32:35], v[180:183], v[132:135]
    ds_read_b64_tr_b16 v[50:51], v248 offset:13312
    v_mfma_f32_16x16x32_bf16 v[136:139], v[36:39], v[176:179], v[136:139]
    ds_read_b64_tr_b16 v[52:53], v249 offset:12288
    v_mfma_f32_16x16x32_bf16 v[140:143], v[36:39], v[180:183], v[140:143]
    ds_read_b64_tr_b16 v[54:55], v249 offset:13312
    buffer_load_dwordx4 v[112:115], v23, s[60:63], s25 offen offset:0 sc1
    s_waitcnt lgkmcnt(4)
    v_mfma_f32_16x16x32_bf16 v[144:147], v[40:43], v[176:179], v[144:147]
    ds_read_b64_tr_b16 v[56:57], v250 offset:12288
    v_mfma_f32_16x16x32_bf16 v[148:151], v[40:43], v[180:183], v[148:151]
    ds_read_b64_tr_b16 v[58:59], v250 offset:13312
    v_mfma_f32_16x16x32_bf16 v[152:155], v[44:47], v[176:179], v[152:155]
    ds_read_b64_tr_b16 v[60:61], v251 offset:12288
    v_mfma_f32_16x16x32_bf16 v[156:159], v[44:47], v[180:183], v[156:159]
    ds_read_b64_tr_b16 v[62:63], v251 offset:13312
    buffer_load_dwordx4 v[116:119], v23, s[60:63], s25 offen offset:1024 sc1
    v_add_u32 v244, s36, v240
    v_add_u32 v245, s36, v241
    v_add_u32 v246, s36, v242
    v_add_u32 v247, s36, v243
    s_waitcnt vmcnt(14) lgkmcnt(4)
    v_mfma_f32_16x16x32_bf16 v[128:131], v[48:51], v[184:187], v[128:131]
    ds_read_b64_tr_b16 v[32:33], v244 offset:0
    v_mfma_f32_16x16x32_bf16 v[132:135], v[48:51], v[188:191], v[132:135]
    ds_read_b64_tr_b16 v[34:35], v244 offset:1024
    v_mfma_f32_16x16x32_bf16 v[136:139], v[52:55], v[184:187], v[136:139]
    ds_read_b64_tr_b16 v[36:37], v245 offset:0
    v_mfma_f32_16x16x32_bf16 v[140:143], v[52:55], v[188:191], v[140:143]
    ds_read_b64_tr_b16 v[38:39], v245 offset:1024
    buffer_load_dwordx4 v[120:123], v23, s[60:63], s25 offen offset:2048 sc1
    s_waitcnt lgkmcnt(4)
    v_mfma_f32_16x16x32_bf16 v[144:147], v[56:59], v[184:187], v[144:147]
    ds_read_b64_tr_b16 v[40:41], v246 offset:0
    v_mfma_f32_16x16x32_bf16 v[148:151], v[56:59], v[188:191], v[148:151]
    ds_read_b64_tr_b16 v[42:43], v246 offset:1024
    v_mfma_f32_16x16x32_bf16 v[152:155], v[60:63], v[184:187], v[152:155]
    ds_read_b64_tr_b16 v[44:45], v247 offset:0
    v_mfma_f32_16x16x32_bf16 v[156:159], v[60:63], v[188:191], v[156:159]
    ds_read_b64_tr_b16 v[46:47], v247 offset:1024
    buffer_load_dwordx4 v[124:127], v23, s[60:63], s25 offen offset:3072 sc1
    s_waitcnt vmcnt(14) lgkmcnt(4)
    v_mfma_f32_16x16x32_bf16 v[128:131], v[32:35], v[64:67], v[128:131]
    ds_read_b64_tr_b16 v[48:49], v244 offset:4096
    v_mfma_f32_16x16x32_bf16 v[132:135], v[32:35], v[68:71], v[132:135]
    ds_read_b64_tr_b16 v[50:51], v244 offset:5120
    v_mfma_f32_16x16x32_bf16 v[136:139], v[36:39], v[64:67], v[136:139]
    ds_read_b64_tr_b16 v[52:53], v245 offset:4096
    v_mfma_f32_16x16x32_bf16 v[140:143], v[36:39], v[68:71], v[140:143]
    ds_read_b64_tr_b16 v[54:55], v245 offset:5120
    buffer_load_dwordx4 v[160:163], v23, s[60:63], s26 offen offset:0 sc1
    s_waitcnt lgkmcnt(4)
    v_mfma_f32_16x16x32_bf16 v[144:147], v[40:43], v[64:67], v[144:147]
    ds_read_b64_tr_b16 v[56:57], v246 offset:4096
    v_mfma_f32_16x16x32_bf16 v[148:151], v[40:43], v[68:71], v[148:151]
    ds_read_b64_tr_b16 v[58:59], v246 offset:5120
    v_mfma_f32_16x16x32_bf16 v[152:155], v[44:47], v[64:67], v[152:155]
    ds_read_b64_tr_b16 v[60:61], v247 offset:4096
    v_mfma_f32_16x16x32_bf16 v[156:159], v[44:47], v[68:71], v[156:159]
    ds_read_b64_tr_b16 v[62:63], v247 offset:5120
    buffer_load_dwordx4 v[164:167], v23, s[60:63], s26 offen offset:1024 sc1
    s_waitcnt vmcnt(14) lgkmcnt(4)
    v_mfma_f32_16x16x32_bf16 v[128:131], v[48:51], v[72:75], v[128:131]
    ds_read_b64_tr_b16 v[32:33], v244 offset:8192
    v_mfma_f32_16x16x32_bf16 v[132:135], v[48:51], v[76:79], v[132:135]
    ds_read_b64_tr_b16 v[34:35], v244 offset:9216
    v_mfma_f32_16x16x32_bf16 v[136:139], v[52:55], v[72:75], v[136:139]
    ds_read_b64_tr_b16 v[36:37], v245 offset:8192
    v_mfma_f32_16x16x32_bf16 v[140:143], v[52:55], v[76:79], v[140:143]
    ds_read_b64_tr_b16 v[38:39], v245 offset:9216
    buffer_load_dwordx4 v[168:171], v23, s[60:63], s26 offen offset:2048 sc1
    s_waitcnt lgkmcnt(4)
    v_mfma_f32_16x16x32_bf16 v[144:147], v[56:59], v[72:75], v[144:147]
    ds_read_b64_tr_b16 v[40:41], v246 offset:8192
    v_mfma_f32_16x16x32_bf16 v[148:151], v[56:59], v[76:79], v[148:151]
    ds_read_b64_tr_b16 v[42:43], v246 offset:9216
    v_mfma_f32_16x16x32_bf16 v[152:155], v[60:63], v[72:75], v[152:155]
    ds_read_b64_tr_b16 v[44:45], v247 offset:8192
    v_mfma_f32_16x16x32_bf16 v[156:159], v[60:63], v[76:79], v[156:159]
    ds_read_b64_tr_b16 v[46:47], v247 offset:9216
    buffer_load_dwordx4 v[172:175], v23, s[60:63], s26 offen offset:3072 sc1
    s_waitcnt vmcnt(14) lgkmcnt(4)
    v_mfma_f32_16x16x32_bf16 v[128:131], v[32:35], v[80:83], v[128:131]
    ds_read_b64_tr_b16 v[48:49], v244 offset:12288
    v_mfma_f32_16x16x32_bf16 v[132:135], v[32:35], v[84:87], v[132:135]
    ds_read_b64_tr_b16 v[50:51], v244 offset:13312
    v_mfma_f32_16x16x32_bf16 v[136:139], v[36:39], v[80:83], v[136:139]
    ds_read_b64_tr_b16 v[52:53], v245 offset:12288
    v_mfma_f32_16x16x32_bf16 v[140:143], v[36:39], v[84:87], v[140:143]
    ds_read_b64_tr_b16 v[54:55], v245 offset:13312
    buffer_load_dwordx4 v[176:179], v23, s[60:63], s27 offen offset:0 sc1
    s_waitcnt lgkmcnt(4)
    v_mfma_f32_16x16x32_bf16 v[144:147], v[40:43], v[80:83], v[144:147]
    ds_read_b64_tr_b16 v[56:57], v246 offset:12288
    v_mfma_f32_16x16x32_bf16 v[148:151], v[40:43], v[84:87], v[148:151]
    ds_read_b64_tr_b16 v[58:59], v246 offset:13312
    v_mfma_f32_16x16x32_bf16 v[152:155], v[44:47], v[80:83], v[152:155]
    ds_read_b64_tr_b16 v[60:61], v247 offset:12288
    v_mfma_f32_16x16x32_bf16 v[156:159], v[44:47], v[84:87], v[156:159]
    ds_read_b64_tr_b16 v[62:63], v247 offset:13312
    buffer_load_dwordx4 v[180:183], v23, s[60:63], s27 offen offset:1024 sc1
    v_add_u32 v248, s37, v240
    v_add_u32 v249, s37, v241
    v_add_u32 v250, s37, v242
    v_add_u32 v251, s37, v243
    s_waitcnt vmcnt(14) lgkmcnt(4)
    v_mfma_f32_16x16x32_bf16 v[128:131], v[48:51], v[88:91], v[128:131]
    ds_read_b64_tr_b16 v[32:33], v248 offset:0
    v_mfma_f32_16x16x32_bf16 v[132:135], v[48:51], v[92:95], v[132:135]
    ds_read_b64_tr_b16 v[34:35], v248 offset:1024
    v_mfma_f32_16x16x32_bf16 v[136:139], v[52:55], v[88:91], v[136:139]
    ds_read_b64_tr_b16 v[36:37], v249 offset:0
    v_mfma_f32_16x16x32_bf16 v[140:143], v[52:55], v[92:95], v[140:143]
    ds_read_b64_tr_b16 v[38:39], v249 offset:1024
    buffer_load_dwordx4 v[184:187], v23, s[60:63], s27 offen offset:2048 sc1
    s_waitcnt lgkmcnt(4)
    v_mfma_f32_16x16x32_bf16 v[144:147], v[56:59], v[88:91], v[144:147]
    ds_read_b64_tr_b16 v[40:41], v250 offset:0
    v_mfma_f32_16x16x32_bf16 v[148:151], v[56:59], v[92:95], v[148:151]
    ds_read_b64_tr_b16 v[42:43], v250 offset:1024
    v_mfma_f32_16x16x32_bf16 v[152:155], v[60:63], v[88:91], v[152:155]
    ds_read_b64_tr_b16 v[44:45], v251 offset:0
    v_mfma_f32_16x16x32_bf16 v[156:159], v[60:63], v[92:95], v[156:159]
    ds_read_b64_tr_b16 v[46:47], v251 offset:1024
    buffer_load_dwordx4 v[188:191], v23, s[60:63], s27 offen offset:3072 sc1
    s_waitcnt vmcnt(14) lgkmcnt(4)
    v_mfma_f32_16x16x32_bf16 v[128:131], v[32:35], v[96:99], v[128:131]
    ds_read_b64_tr_b16 v[48:49], v248 offset:4096
    v_mfma_f32_16x16x32_bf16 v[132:135], v[32:35], v[100:103], v[132:135]
    ds_read_b64_tr_b16 v[50:51], v248 offset:5120
    v_mfma_f32_16x16x32_bf16 v[136:139], v[36:39], v[96:99], v[136:139]
    ds_read_b64_tr_b16 v[52:53], v249 offset:4096
    v_mfma_f32_16x16x32_bf16 v[140:143], v[36:39], v[100:103], v[140:143]
    ds_read_b64_tr_b16 v[54:55], v249 offset:5120
    buffer_load_dwordx4 v[64:67], v23, s[60:63], s28 offen offset:0 sc1
    s_waitcnt lgkmcnt(4)
    v_mfma_f32_16x16x32_bf16 v[144:147], v[40:43], v[96:99], v[144:147]
    ds_read_b64_tr_b16 v[56:57], v250 offset:4096
    v_mfma_f32_16x16x32_bf16 v[148:151], v[40:43], v[100:103], v[148:151]
    ds_read_b64_tr_b16 v[58:59], v250 offset:5120
    v_mfma_f32_16x16x32_bf16 v[152:155], v[44:47], v[96:99], v[152:155]
    ds_read_b64_tr_b16 v[60:61], v251 offset:4096
    v_mfma_f32_16x16x32_bf16 v[156:159], v[44:47], v[100:103], v[156:159]
    ds_read_b64_tr_b16 v[62:63], v251 offset:5120
    buffer_load_dwordx4 v[68:71], v23, s[60:63], s28 offen offset:1024 sc1
    s_waitcnt vmcnt(14) lgkmcnt(4)
    v_mfma_f32_16x16x32_bf16 v[128:131], v[48:51], v[104:107], v[128:131]
    ds_read_b64_tr_b16 v[32:33], v248 offset:8192
    v_mfma_f32_16x16x32_bf16 v[132:135], v[48:51], v[108:111], v[132:135]
    ds_read_b64_tr_b16 v[34:35], v248 offset:9216
    v_mfma_f32_16x16x32_bf16 v[136:139], v[52:55], v[104:107], v[136:139]
    ds_read_b64_tr_b16 v[36:37], v249 offset:8192
    v_mfma_f32_16x16x32_bf16 v[140:143], v[52:55], v[108:111], v[140:143]
    ds_read_b64_tr_b16 v[38:39], v249 offset:9216
    buffer_load_dwordx4 v[72:75], v23, s[60:63], s28 offen offset:2048 sc1
    s_waitcnt lgkmcnt(4)
    v_mfma_f32_16x16x32_bf16 v[144:147], v[56:59], v[104:107], v[144:147]
    ds_read_b64_tr_b16 v[40:41], v250 offset:8192
    v_mfma_f32_16x16x32_bf16 v[148:151], v[56:59], v[108:111], v[148:151]
    ds_read_b64_tr_b16 v[42:43], v250 offset:9216
    v_mfma_f32_16x16x32_bf16 v[152:155], v[60:63], v[104:107], v[152:155]
    ds_read_b64_tr_b16 v[44:45], v251 offset:8192
    v_mfma_f32_16x16x32_bf16 v[156:159], v[60:63], v[108:111], v[156:159]
    ds_read_b64_tr_b16 v[46:47], v251 offset:9216
    buffer_load_dwordx4 v[76:79], v23, s[60:63], s28 offen offset:3072 sc1
    s_waitcnt vmcnt(14) lgkmcnt(4)
    v_mfma_f32_16x16x32_bf16 v[128:131], v[32:35], v[112:115], v[128:131]
    ds_read_b64_tr_b16 v[48:49], v248 offset:12288
    v_mfma_f32_16x16x32_bf16 v[132:135], v[32:35], v[116:119], v[132:135]
    ds_read_b64_tr_b16 v[50:51], v248 offset:13312
    v_mfma_f32_16x16x32_bf16 v[136:139], v[36:39], v[112:115], v[136:139]
    ds_read_b64_tr_b16 v[52:53], v249 offset:12288
    v_mfma_f32_16x16x32_bf16 v[140:143], v[36:39], v[116:119], v[140:143]
    ds_read_b64_tr_b16 v[54:55], v249 offset:13312
    buffer_load_dwordx4 v[80:83], v23, s[60:63], s29 offen offset:0 sc1
    s_waitcnt lgkmcnt(4)
    v_mfma_f32_16x16x32_bf16 v[144:147], v[40:43], v[112:115], v[144:147]
    ds_read_b64_tr_b16 v[56:57], v250 offset:12288
    v_mfma_f32_16x16x32_bf16 v[148:151], v[40:43], v[116:119], v[148:151]
    ds_read_b64_tr_b16 v[58:59], v250 offset:13312
    v_mfma_f32_16x16x32_bf16 v[152:155], v[44:47], v[112:115], v[152:155]
    ds_read_b64_tr_b16 v[60:61], v251 offset:12288
    v_mfma_f32_16x16x32_bf16 v[156:159], v[44:47], v[116:119], v[156:159]
    ds_read_b64_tr_b16 v[62:63], v251 offset:13312
    buffer_load_dwordx4 v[84:87], v23, s[60:63], s29 offen offset:1024 sc1
    v_add_u32 v244, s38, v240
    v_add_u32 v245, s38, v241
    v_add_u32 v246, s38, v242
    v_add_u32 v247, s38, v243
    s_waitcnt vmcnt(14) lgkmcnt(4)
    v_mfma_f32_16x16x32_bf16 v[128:131], v[48:51], v[120:123], v[128:131]
    ds_read_b64_tr_b16 v[32:33], v244 offset:0
    v_mfma_f32_16x16x32_bf16 v[132:135], v[48:51], v[124:127], v[132:135]
    ds_read_b64_tr_b16 v[34:35], v244 offset:1024
    v_mfma_f32_16x16x32_bf16 v[136:139], v[52:55], v[120:123], v[136:139]
    ds_read_b64_tr_b16 v[36:37], v245 offset:0
    v_mfma_f32_16x16x32_bf16 v[140:143], v[52:55], v[124:127], v[140:143]
    ds_read_b64_tr_b16 v[38:39], v245 offset:1024
    buffer_load_dwordx4 v[88:91], v23, s[60:63], s29 offen offset:2048 sc1
    s_waitcnt lgkmcnt(4)
    v_mfma_f32_16x16x32_bf16 v[144:147], v[56:59], v[120:123], v[144:147]
    ds_read_b64_tr_b16 v[40:41], v246 offset:0
    v_mfma_f32_16x16x32_bf16 v[148:151], v[56:59], v[124:127], v[148:151]
    ds_read_b64_tr_b16 v[42:43], v246 offset:1024
    v_mfma_f32_16x16x32_bf16 v[152:155], v[60:63], v[120:123], v[152:155]
    ds_read_b64_tr_b16 v[44:45], v247 offset:0
    v_mfma_f32_16x16x32_bf16 v[156:159], v[60:63], v[124:127], v[156:159]
    ds_read_b64_tr_b16 v[46:47], v247 offset:1024
    buffer_load_dwordx4 v[92:95], v23, s[60:63], s29 offen offset:3072 sc1
    s_waitcnt vmcnt(14) lgkmcnt(4)
    v_mfma_f32_16x16x32_bf16 v[128:131], v[32:35], v[160:163], v[128:131]
    ds_read_b64_tr_b16 v[48:49], v244 offset:4096
    v_mfma_f32_16x16x32_bf16 v[132:135], v[32:35], v[164:167], v[132:135]
    ds_read_b64_tr_b16 v[50:51], v244 offset:5120
    v_mfma_f32_16x16x32_bf16 v[136:139], v[36:39], v[160:163], v[136:139]
    ds_read_b64_tr_b16 v[52:53], v245 offset:4096
    v_mfma_f32_16x16x32_bf16 v[140:143], v[36:39], v[164:167], v[140:143]
    ds_read_b64_tr_b16 v[54:55], v245 offset:5120
    s_waitcnt lgkmcnt(4)
    v_mfma_f32_16x16x32_bf16 v[144:147], v[40:43], v[160:163], v[144:147]
    ds_read_b64_tr_b16 v[56:57], v246 offset:4096
    v_mfma_f32_16x16x32_bf16 v[148:151], v[40:43], v[164:167], v[148:151]
    ds_read_b64_tr_b16 v[58:59], v246 offset:5120
    v_mfma_f32_16x16x32_bf16 v[152:155], v[44:47], v[160:163], v[152:155]
    ds_read_b64_tr_b16 v[60:61], v247 offset:4096
    v_mfma_f32_16x16x32_bf16 v[156:159], v[44:47], v[164:167], v[156:159]
    ds_read_b64_tr_b16 v[62:63], v247 offset:5120
    s_waitcnt vmcnt(12) lgkmcnt(4)
    v_mfma_f32_16x16x32_bf16 v[128:131], v[48:51], v[168:171], v[128:131]
    ds_read_b64_tr_b16 v[32:33], v244 offset:8192
    v_mfma_f32_16x16x32_bf16 v[132:135], v[48:51], v[172:175], v[132:135]
    ds_read_b64_tr_b16 v[34:35], v244 offset:9216
    v_mfma_f32_16x16x32_bf16 v[136:139], v[52:55], v[168:171], v[136:139]
    ds_read_b64_tr_b16 v[36:37], v245 offset:8192
    v_mfma_f32_16x16x32_bf16 v[140:143], v[52:55], v[172:175], v[140:143]
    ds_read_b64_tr_b16 v[38:39], v245 offset:9216
    s_waitcnt lgkmcnt(4)
    v_mfma_f32_16x16x32_bf16 v[144:147], v[56:59], v[168:171], v[144:147]
    ds_read_b64_tr_b16 v[40:41], v246 offset:8192
    v_mfma_f32_16x16x32_bf16 v[148:151], v[56:59], v[172:175], v[148:151]
    ds_read_b64_tr_b16 v[42:43], v246 offset:9216
    v_mfma_f32_16x16x32_bf16 v[152:155], v[60:63], v[168:171], v[152:155]
    ds_read_b64_tr_b16 v[44:45], v247 offset:8192
    v_mfma_f32_16x16x32_bf16 v[156:159], v[60:63], v[172:175], v[156:159]
    ds_read_b64_tr_b16 v[46:47], v247 offset:9216
    s_waitcnt vmcnt(10) lgkmcnt(4)
    v_mfma_f32_16x16x32_bf16 v[128:131], v[32:35], v[176:179], v[128:131]
    ds_read_b64_tr_b16 v[48:49], v244 offset:12288
    v_mfma_f32_16x16x32_bf16 v[132:135], v[32:35], v[180:183], v[132:135]
    ds_read_b64_tr_b16 v[50:51], v244 offset:13312
    v_mfma_f32_16x16x32_bf16 v[136:139], v[36:39], v[176:179], v[136:139]
    ds_read_b64_tr_b16 v[52:53], v245 offset:12288
    v_mfma_f32_16x16x32_bf16 v[140:143], v[36:39], v[180:183], v[140:143]
    ds_read_b64_tr_b16 v[54:55], v245 offset:13312
    s_waitcnt lgkmcnt(4)
    v_mfma_f32_16x16x32_bf16 v[144:147], v[40:43], v[176:179], v[144:147]
    ds_read_b64_tr_b16 v[56:57], v246 offset:12288
    v_mfma_f32_16x16x32_bf16 v[148:151], v[40:43], v[180:183], v[148:151]
    ds_read_b64_tr_b16 v[58:59], v246 offset:13312
    v_mfma_f32_16x16x32_bf16 v[152:155], v[44:47], v[176:179], v[152:155]
    ds_read_b64_tr_b16 v[60:61], v247 offset:12288
    v_mfma_f32_16x16x32_bf16 v[156:159], v[44:47], v[180:183], v[156:159]
    ds_read_b64_tr_b16 v[62:63], v247 offset:13312
    v_add_u32 v248, s39, v240
    v_add_u32 v249, s39, v241
    v_add_u32 v250, s39, v242
    v_add_u32 v251, s39, v243
    s_waitcnt vmcnt(8) lgkmcnt(4)
    v_mfma_f32_16x16x32_bf16 v[128:131], v[48:51], v[184:187], v[128:131]
    ds_read_b64_tr_b16 v[32:33], v248 offset:0
    v_mfma_f32_16x16x32_bf16 v[132:135], v[48:51], v[188:191], v[132:135]
    ds_read_b64_tr_b16 v[34:35], v248 offset:1024
    v_mfma_f32_16x16x32_bf16 v[136:139], v[52:55], v[184:187], v[136:139]
    ds_read_b64_tr_b16 v[36:37], v248 offset:4096
    v_mfma_f32_16x16x32_bf16 v[140:143], v[52:55], v[188:191], v[140:143]
    ds_read_b64_tr_b16 v[38:39], v248 offset:5120
    s_waitcnt lgkmcnt(4)
    v_mfma_f32_16x16x32_bf16 v[144:147], v[56:59], v[184:187], v[144:147]
    ds_read_b64_tr_b16 v[40:41], v248 offset:8192
    v_mfma_f32_16x16x32_bf16 v[148:151], v[56:59], v[188:191], v[148:151]
    ds_read_b64_tr_b16 v[42:43], v248 offset:9216
    v_mfma_f32_16x16x32_bf16 v[152:155], v[60:63], v[184:187], v[152:155]
    ds_read_b64_tr_b16 v[44:45], v248 offset:12288
    v_mfma_f32_16x16x32_bf16 v[156:159], v[60:63], v[188:191], v[156:159]
    ds_read_b64_tr_b16 v[46:47], v248 offset:13312
    s_waitcnt vmcnt(0)
    s_cmp_lg_u32 s3, s65
    s_cbranch_scc1 L_send
    s_waitcnt lgkmcnt(4)
    v_mfma_f32_16x16x32_bf16 v[128:131], v[32:35], v[64:67], v[128:131]
    ds_read_b64_tr_b16 v[48:49], v249 offset:0
    v_mfma_f32_16x16x32_bf16 v[132:135], v[32:35], v[68:71], v[132:135]
    ds_read_b64_tr_b16 v[50:51], v249 offset:1024
    v_mfma_f32_16x16x32_bf16 v[128:131], v[36:39], v[72:75], v[128:131]
    ds_read_b64_tr_b16 v[52:53], v249 offset:4096
    v_mfma_f32_16x16x32_bf16 v[132:135], v[36:39], v[76:79], v[132:135]
    ds_read_b64_tr_b16 v[54:55], v249 offset:5120
    s_waitcnt lgkmcnt(4)
    v_mfma_f32_16x16x32_bf16 v[128:131], v[40:43], v[80:83], v[128:131]
    ds_read_b64_tr_b16 v[56:57], v249 offset:8192
    v_mfma_f32_16x16x32_bf16 v[132:135], v[40:43], v[84:87], v[132:135]
    ds_read_b64_tr_b16 v[58:59], v249 offset:9216
    v_mfma_f32_16x16x32_bf16 v[128:131], v[44:47], v[88:91], v[128:131]
    ds_read_b64_tr_b16 v[60:61], v249 offset:12288
    v_mfma_f32_16x16x32_bf16 v[132:135], v[44:47], v[92:95], v[132:135]
    ds_read_b64_tr_b16 v[62:63], v249 offset:13312
    s_waitcnt lgkmcnt(4)
    v_mfma_f32_16x16x32_bf16 v[136:139], v[48:51], v[64:67], v[136:139]
    ds_read_b64_tr_b16 v[32:33], v250 offset:0
    v_mfma_f32_16x16x32_bf16 v[140:143], v[48:51], v[68:71], v[140:143]
    ds_read_b64_tr_b16 v[34:35], v250 offset:1024
    v_mfma_f32_16x16x32_bf16 v[136:139], v[52:55], v[72:75], v[136:139]
    ds_read_b64_tr_b16 v[36:37], v250 offset:4096
    v_mfma_f32_16x16x32_bf16 v[140:143], v[52:55], v[76:79], v[140:143]
    ds_read_b64_tr_b16 v[38:39], v250 offset:5120
    s_waitcnt lgkmcnt(4)
    v_mfma_f32_16x16x32_bf16 v[136:139], v[56:59], v[80:83], v[136:139]
    ds_read_b64_tr_b16 v[40:41], v250 offset:8192
    v_mfma_f32_16x16x32_bf16 v[140:143], v[56:59], v[84:87], v[140:143]
    ds_read_b64_tr_b16 v[42:43], v250 offset:9216
    v_mfma_f32_16x16x32_bf16 v[136:139], v[60:63], v[88:91], v[136:139]
    ds_read_b64_tr_b16 v[44:45], v250 offset:12288
    v_mfma_f32_16x16x32_bf16 v[140:143], v[60:63], v[92:95], v[140:143]
    ds_read_b64_tr_b16 v[46:47], v250 offset:13312
    s_waitcnt lgkmcnt(4)
    v_mfma_f32_16x16x32_bf16 v[144:147], v[32:35], v[64:67], v[144:147]
    ds_read_b64_tr_b16 v[48:49], v251 offset:0
    v_mfma_f32_16x16x32_bf16 v[148:151], v[32:35], v[68:71], v[148:151]
    ds_read_b64_tr_b16 v[50:51], v251 offset:1024
    v_mfma_f32_16x16x32_bf16 v[144:147], v[36:39], v[72:75], v[144:147]
    ds_read_b64_tr_b16 v[52:53], v251 offset:4096
    v_mfma_f32_16x16x32_bf16 v[148:151], v[36:39], v[76:79], v[148:151]
    ds_read_b64_tr_b16 v[54:55], v251 offset:5120
    s_waitcnt lgkmcnt(4)
    v_mfma_f32_16x16x32_bf16 v[144:147], v[40:43], v[80:83], v[144:147]
    ds_read_b64_tr_b16 v[56:57], v251 offset:8192
    v_mfma_f32_16x16x32_bf16 v[148:151], v[40:43], v[84:87], v[148:151]
    ds_read_b64_tr_b16 v[58:59], v251 offset:9216
    v_mfma_f32_16x16x32_bf16 v[144:147], v[44:47], v[88:91], v[144:147]
    ds_read_b64_tr_b16 v[60:61], v251 offset:12288
    v_mfma_f32_16x16x32_bf16 v[148:151], v[44:47], v[92:95], v[148:151]
    ds_read_b64_tr_b16 v[62:63], v251 offset:13312
    s_waitcnt lgkmcnt(4)
    v_mfma_f32_16x16x32_bf16 v[152:155], v[48:51], v[64:67], v[152:155]
    v_mfma_f32_16x16x32_bf16 v[156:159], v[48:51], v[68:71], v[156:159]
    v_mfma_f32_16x16x32_bf16 v[152:155], v[52:55], v[72:75], v[152:155]
    v_mfma_f32_16x16x32_bf16 v[156:159], v[52:55], v[76:79], v[156:159]
    s_waitcnt lgkmcnt(0)
    v_mfma_f32_16x16x32_bf16 v[152:155], v[56:59], v[80:83], v[152:155]
    v_mfma_f32_16x16x32_bf16 v[156:159], v[56:59], v[84:87], v[156:159]
    v_mfma_f32_16x16x32_bf16 v[152:155], v[60:63], v[88:91], v[152:155]
    v_mfma_f32_16x16x32_bf16 v[156:159], v[60:63], v[92:95], v[156:159]
    s_add_u32 s6, s65, 1
    s_and_b32 s6, s6, 3
    s_lshl_b32 s6, s6, 18
    s_add_u32 s16, s41, s6
    s_add_u32 s17, s16, 4096
    s_add_u32 s6, s65, 2
    s_and_b32 s6, s6, 3
    s_lshl_b32 s6, s6, 18
    s_add_u32 s18, s41, s6
    s_add_u32 s19, s18, 4096
    s_add_u32 s6, s65, 3
    s_and_b32 s6, s6, 3
    s_lshl_b32 s6, s6, 18
    s_add_u32 s20, s41, s6
    s_add_u32 s21, s20, 4096
    v_add_u32 v2, s65, v1
    v_and_b32 v2, 3, v2
    v_lshlrev_b32 v2, 12, v2
    s_mov_b32 s30, 14
    s_mov_b32 s7, 262144
L_p2:
    s_mov_b64 exec, 14
    buffer_load_dword v4, v2, s[60:63], s48 offen sc1
    s_waitcnt vmcnt(0)
    v_cmp_eq_u32 vcc, v4, v24
    s_mov_b64 exec, -1
    s_and_b32 s31, vcc_lo, s30
    s_andn2_b32 s30, s30, s31
    s_bitcmp1_b32 s31, 1
    s_cbranch_scc0 L_p2n1
    buffer_load_dwordx4 v[32:35], v23, s[60:63], s16 offen offset:0 sc1
    buffer_load_dwordx4 v[36:39], v23, s[60:63], s16 offen offset:1024 sc1
    buffer_load_dwordx4 v[40:43], v23, s[60:63], s16 offen offset:2048 sc1
    buffer_load_dwordx4 v[44:47], v23, s[60:63], s16 offen offset:3072 sc1
    buffer_load_dwordx4 v[48:51], v23, s[60:63], s17 offen offset:0 sc1
    buffer_load_dwordx4 v[52:55], v23, s[60:63], s17 offen offset:1024 sc1
    buffer_load_dwordx4 v[56:59], v23, s[60:63], s17 offen offset:2048 sc1
    buffer_load_dwordx4 v[60:63], v23, s[60:63], s17 offen offset:3072 sc1
L_p2n1:
    s_bitcmp1_b32 s31, 2
    s_cbranch_scc0 L_p2n2
    buffer_load_dwordx4 v[64:67], v23, s[60:63], s18 offen offset:0 sc1
    buffer_load_dwordx4 v[68:71], v23, s[60:63], s18 offen offset:1024 sc1
    buffer_load_dwordx4 v[72:75], v23, s[60:63], s18 offen offset:2048 sc1
    buffer_load_dwordx4 v[76:79], v23, s[60:63], s18 offen offset:3072 sc1
    buffer_load_dwordx4 v[80:83], v23, s[60:63], s19 offen offset:0 sc1
    buffer_load_dwordx4 v[84:87], v23, s[60:63], s19 offen offset:1024 sc1
    buffer_load_dwordx4 v[88:91], v23, s[60:63], s19 offen offset:2048 sc1
    buffer_load_dwordx4 v[92:95], v23, s[60:63], s19 offen offset:3072 sc1
L_p2n2:
    s_bitcmp1_b32 s31, 3
    s_cbranch_scc0 L_p2n3
    buffer_load_dwordx4 v[96:99], v23, s[60:63], s20 offen offset:0 sc1
    buffer_load_dwordx4 v[100:103], v23, s[60:63], s20 offen offset:1024 sc1
    buffer_load_dwordx4 v[104:107], v23, s[60:63], s20 offen offset:2048 sc1
    buffer_load_dwordx4 v[108:111], v23, s[60:63], s20 offen offset:3072 sc1
    buffer_load_dwordx4 v[112:115], v23, s[60:63], s21 offen offset:0 sc1
    buffer_load_dwordx4 v[116:119], v23, s[60:63], s21 offen offset:1024 sc1
    buffer_load_dwordx4 v[120:123], v23, s[60:63], s21 offen offset:2048 sc1
    buffer_load_dwordx4 v[124:127], v23, s[60:63], s21 offen offset:3072 sc1
L_p2n3:
    s_cmp_eq_u32 s30, 0
    s_cbranch_scc1 L_p2_ok
    s_sub_u32 s7, s7, 1
    s_cmp_lg_u32 s7, 0
    s_cbranch_scc1 L_p2
    s_endpgm
L_p2_ok:
    s_mov_b32 s6, 0xffff0000
    s_waitcnt vmcnt(7)
    v_add_f32 v128, v128, v32
    v_add_f32 v129, v129, v33
    v_add_f32 v130, v130, v34
    v_add_f32 v131, v131, v35
    v_add_f32 v64, v64, v96
    v_add_f32 v65, v65, v97
    v_add_f32 v66, v66, v98
    v_add_f32 v67, v67, v99
    v_add_f32 v128, v128, v64
    v_add_f32 v129, v129, v65
    v_add_f32 v130, v130, v66
    v_add_f32 v131, v131, v67
    s_waitcnt vmcnt(6)
    v_add_f32 v132, v132, v36
    v_add_f32 v133, v133, v37
    v_add_f32 v134, v134, v38
    v_add_f32 v135, v135, v39
    v_add_f32 v68, v68, v100
    v_add_f32 v69, v69, v101
    v_add_f32 v70, v70, v102
    v_add_f32 v71, v71, v103
    v_add_f32 v132, v132, v68
    v_add_f32 v133, v133, v69
    v_add_f32 v134, v134, v70
    v_add_f32 v135, v135, v71
    s_waitcnt vmcnt(5)
    v_add_f32 v136, v136, v40
    v_add_f32 v137, v137, v41
    v_add_f32 v138, v138, v42
    v_add_f32 v139, v139, v43
    v_add_f32 v72, v72, v104
    v_add_f32 v73, v73, v105
    v_add_f32 v74, v74, v106
    v_add_f32 v75, v75, v107
    v_add_f32 v136, v136, v72
    v_add_f32 v137, v137, v73
    v_add_f32 v138, v138, v74
    v_add_f32 v139, v139, v75
    s_waitcnt vmcnt(4)
    v_add_f32 v140, v140, v44
    v_add_f32 v141, v141, v45
    v_add_f32 v142, v142, v46
    v_add_f32 v143, v143, v47
    v_add_f32 v76, v76, v108
    v_add_f32 v77, v77, v109
    v_add_f32 v78, v78, v110
    v_add_f32 v79, v79, v111
    v_add_f32 v140, v140, v76
    v_add_f32 v141, v141, v77
    v_add_f32 v142, v142, v78
    v_add_f32 v143, v143, v79
    v_cvt_pk_bf16_f32 v192, v128, v129
    v_cvt_pk_bf16_f32 v193, v130, v131
    v_cvt_pk_bf16_f32 v194, v136, v137
    v_cvt_pk_bf16_f32 v195, v138, v139
    v_cvt_pk_bf16_f32 v196, v132, v133
    v_cvt_pk_bf16_f32 v197, v134, v135
    v_cvt_pk_bf16_f32 v198, v140, v141
    v_cvt_pk_bf16_f32 v199, v142, v143
    v_permlane16_swap_b32 v192, v194
    v_permlane16_swap_b32 v193, v195
    buffer_store_dwordx4 v[192:195], v22, s[52:55], s50 offen offset:0
    v_permlane16_swap_b32 v196, v198
    v_permlane16_swap_b32 v197, v199
    buffer_store_dwordx4 v[196:199], v22, s[52:55], s51 offen offset:0
    s_waitcnt vmcnt(5)
    v_add_f32 v144, v144, v48
    v_add_f32 v145, v145, v49
    v_add_f32 v146, v146, v50
    v_add_f32 v147, v147, v51
    v_add_f32 v80, v80, v112
    v_add_f32 v81, v81, v113
    v_add_f32 v82, v82, v114
    v_add_f32 v83, v83, v115
    v_add_f32 v144, v144, v80
    v_add_f32 v145, v145, v81
    v_add_f32 v146, v146, v82
    v_add_f32 v147, v147, v83
    s_waitcnt vmcnt(4)
    v_add_f32 v148, v148, v52
    v_add_f32 v149, v149, v53
    v_add_f32 v150, v150, v54
    v_add_f32 v151, v151, v55
    v_add_f32 v84, v84, v116
    v_add_f32 v85, v85, v117
    v_add_f32 v86, v86, v118
    v_add_f32 v87, v87, v119
    v_add_f32 v148, v148, v84
    v_add_f32 v149, v149, v85
    v_add_f32 v150, v150, v86
    v_add_f32 v151, v151, v87
    s_waitcnt vmcnt(3)
    v_add_f32 v152, v152, v56
    v_add_f32 v153, v153, v57
    v_add_f32 v154, v154, v58
    v_add_f32 v155, v155, v59
    v_add_f32 v88, v88, v120
    v_add_f32 v89, v89, v121
    v_add_f32 v90, v90, v122
    v_add_f32 v91, v91, v123
    v_add_f32 v152, v152, v88
    v_add_f32 v153, v153, v89
    v_add_f32 v154, v154, v90
    v_add_f32 v155, v155, v91
    s_waitcnt vmcnt(2)
    v_add_f32 v156, v156, v60
    v_add_f32 v157, v157, v61
    v_add_f32 v158, v158, v62
    v_add_f32 v159, v159, v63
    v_add_f32 v92, v92, v124
    v_add_f32 v93, v93, v125
    v_add_f32 v94, v94, v126
    v_add_f32 v95, v95, v127
    v_add_f32 v156, v156, v92
    v_add_f32 v157, v157, v93
    v_add_f32 v158, v158, v94
    v_add_f32 v159, v159, v95
    v_cvt_pk_bf16_f32 v200, v144, v145
    v_cvt_pk_bf16_f32 v201, v146, v147
    v_cvt_pk_bf16_f32 v202, v152, v153
    v_cvt_pk_bf16_f32 v203, v154, v155
    v_cvt_pk_bf16_f32 v204, v148, v149
    v_cvt_pk_bf16_f32 v205, v150, v151
    v_cvt_pk_bf16_f32 v206, v156, v157
    v_cvt_pk_bf16_f32 v207, v158, v159
    v_permlane16_swap_b32 v200, v202
    v_permlane16_swap_b32 v201, v203
    buffer_store_dwordx4 v[200:203], v22, s[52:55], s50 offen offset:64
    v_permlane16_swap_b32 v204, v206
    v_permlane16_swap_b32 v205, v207
    buffer_store_dwordx4 v[204:207], v22, s[52:55], s51 offen offset:64
L_end:
    s_endpgm
L_send:
    s_waitcnt lgkmcnt(4)
    v_mfma_f32_16x16x32_bf16 v[128:131], v[32:35], v[64:67], v[128:131]
    ds_read_b64_tr_b16 v[48:49], v249 offset:0
    v_mfma_f32_16x16x32_bf16 v[132:135], v[32:35], v[68:71], v[132:135]
    ds_read_b64_tr_b16 v[50:51], v249 offset:1024
    v_mfma_f32_16x16x32_bf16 v[128:131], v[36:39], v[72:75], v[128:131]
    ds_read_b64_tr_b16 v[52:53], v249 offset:4096
    v_mfma_f32_16x16x32_bf16 v[132:135], v[36:39], v[76:79], v[132:135]
    ds_read_b64_tr_b16 v[54:55], v249 offset:5120
    s_waitcnt lgkmcnt(4)
    v_mfma_f32_16x16x32_bf16 v[128:131], v[40:43], v[80:83], v[128:131]
    ds_read_b64_tr_b16 v[56:57], v249 offset:8192
    v_mfma_f32_16x16x32_bf16 v[132:135], v[40:43], v[84:87], v[132:135]
    ds_read_b64_tr_b16 v[58:59], v249 offset:9216
    v_mfma_f32_16x16x32_bf16 v[128:131], v[44:47], v[88:91], v[128:131]
    ds_read_b64_tr_b16 v[60:61], v249 offset:12288
    v_mfma_f32_16x16x32_bf16 v[132:135], v[44:47], v[92:95], v[132:135]
    ds_read_b64_tr_b16 v[62:63], v249 offset:13312
    s_waitcnt lgkmcnt(4)
    v_mfma_f32_16x16x32_bf16 v[136:139], v[48:51], v[64:67], v[136:139]
    ds_read_b64_tr_b16 v[32:33], v250 offset:0
    v_mfma_f32_16x16x32_bf16 v[140:143], v[48:51], v[68:71], v[140:143]
    ds_read_b64_tr_b16 v[34:35], v250 offset:1024
    v_mfma_f32_16x16x32_bf16 v[136:139], v[52:55], v[72:75], v[136:139]
    ds_read_b64_tr_b16 v[36:37], v250 offset:4096
    v_mfma_f32_16x16x32_bf16 v[140:143], v[52:55], v[76:79], v[140:143]
    ds_read_b64_tr_b16 v[38:39], v250 offset:5120
    s_waitcnt lgkmcnt(4)
    v_mfma_f32_16x16x32_bf16 v[136:139], v[56:59], v[80:83], v[136:139]
    ds_read_b64_tr_b16 v[40:41], v250 offset:8192
    v_mfma_f32_16x16x32_bf16 v[140:143], v[56:59], v[84:87], v[140:143]
    ds_read_b64_tr_b16 v[42:43], v250 offset:9216
    buffer_store_dwordx4 v[128:131], v23, s[60:63], s45 offen offset:0 sc1
    buffer_store_dwordx4 v[132:135], v23, s[60:63], s45 offen offset:1024 sc1
    v_mfma_f32_16x16x32_bf16 v[136:139], v[60:63], v[88:91], v[136:139]
    ds_read_b64_tr_b16 v[44:45], v250 offset:12288
    v_mfma_f32_16x16x32_bf16 v[140:143], v[60:63], v[92:95], v[140:143]
    ds_read_b64_tr_b16 v[46:47], v250 offset:13312
    s_waitcnt lgkmcnt(4)
    v_mfma_f32_16x16x32_bf16 v[144:147], v[32:35], v[64:67], v[144:147]
    ds_read_b64_tr_b16 v[48:49], v251 offset:0
    v_mfma_f32_16x16x32_bf16 v[148:151], v[32:35], v[68:71], v[148:151]
    ds_read_b64_tr_b16 v[50:51], v251 offset:1024
    v_mfma_f32_16x16x32_bf16 v[144:147], v[36:39], v[72:75], v[144:147]
    ds_read_b64_tr_b16 v[52:53], v251 offset:4096
    v_mfma_f32_16x16x32_bf16 v[148:151], v[36:39], v[76:79], v[148:151]
    ds_read_b64_tr_b16 v[54:55], v251 offset:5120
    s_waitcnt lgkmcnt(4)
    v_mfma_f32_16x16x32_bf16 v[144:147], v[40:43], v[80:83], v[144:147]
    ds_read_b64_tr_b16 v[56:57], v251 offset:8192
    v_mfma_f32_16x16x32_bf16 v[148:151], v[40:43], v[84:87], v[148:151]
    ds_read_b64_tr_b16 v[58:59], v251 offset:9216
    buffer_store_dwordx4 v[136:139], v23, s[60:63], s45 offen offset:2048 sc1
    buffer_store_dwordx4 v[140:143], v23, s[60:63], s45 offen offset:3072 sc1
    v_mfma_f32_16x16x32_bf16 v[144:147], v[44:47], v[88:91], v[144:147]
    ds_read_b64_tr_b16 v[60:61], v251 offset:12288
    v_mfma_f32_16x16x32_bf16 v[148:151], v[44:47], v[92:95], v[148:151]
    ds_read_b64_tr_b16 v[62:63], v251 offset:13312
    s_waitcnt lgkmcnt(4)
    v_mfma_f32_16x16x32_bf16 v[152:155], v[48:51], v[64:67], v[152:155]
    v_mfma_f32_16x16x32_bf16 v[156:159], v[48:51], v[68:71], v[156:159]
    v_mfma_f32_16x16x32_bf16 v[152:155], v[52:55], v[72:75], v[152:155]
    v_mfma_f32_16x16x32_bf16 v[156:159], v[52:55], v[76:79], v[156:159]
    s_waitcnt lgkmcnt(0)
    v_mfma_f32_16x16x32_bf16 v[152:155], v[56:59], v[80:83], v[152:155]
    v_mfma_f32_16x16x32_bf16 v[156:159], v[56:59], v[84:87], v[156:159]
    buffer_store_dwordx4 v[144:147], v23, s[60:63], s46 offen offset:0 sc1
    buffer_store_dwordx4 v[148:151], v23, s[60:63], s46 offen offset:1024 sc1
    v_mfma_f32_16x16x32_bf16 v[152:155], v[60:63], v[88:91], v[152:155]
    v_mfma_f32_16x16x32_bf16 v[156:159], v[60:63], v[92:95], v[156:159]
    s_nop 6
    buffer_store_dwordx4 v[152:155], v23, s[60:63], s46 offen offset:2048 sc1
    buffer_store_dwordx4 v[156:159], v23, s[60:63], s46 offen offset:3072 sc1
    s_waitcnt vmcnt(0)
    s_mov_b64 exec, 15
    buffer_store_dwordx4 v[24:27], v23, s[60:63], s47 offen sc1
    s_endpgm
    .p2align 6
L_lrest:
    v_lshl_add_u32 v22, v9, 8, v8
    v_xor_b32 v6, v6, v4
    v_lshlrev_b32 v6, 4, v6
    v_lshl_add_u32 v18, v9, 8, v6
    v_xor_b32 v19, 64, v18
    v_xor_b32 v20, 128, v18
    v_xor_b32 v21, 192, v18
    v_and_b32 v8, 1, v4
    v_lshlrev_b32 v8, 1, v8
    v_xor_b32 v8, v7, v8
    v_lshlrev_b32 v8, 4, v8
    v_add_u32 v24, v5, v8
    v_add_u32 v25, 0x1c00, v24
    v_add_u32 v26, 0x3800, v24
    v_xor_b32 v26, 64, v26
    v_add_u32 v27, 0x5400, v24
    v_xor_b32 v27, 64, v27
    s_lshl_b32 s10, s69, 15
    s_lshl_b32 s11, s65, 20
    s_lshl_b32 s6, s64, 7
    s_add_u32 s11, s11, s6
    s_mov_b32 s36, s18
    s_and_b32 s37, s19, 0xffff
    s_mov_b32 s38, 0x800000
    s_mov_b32 s39, 0x20000
    s_mov_b32 s40, s20
    s_and_b32 s41, s21, 0xffff
    s_mov_b32 s42, 0x800000
    s_mov_b32 s43, 0x20000
    s_mov_b32 s48, s24
    s_and_b32 s49, s25, 0xffff
    s_mov_b32 s50, 0x400000
    s_mov_b32 s51, 0x20000
    s_and_b32 s67, s64, 1
    s_cmp_lg_u32 s67, 0
    s_cbranch_scc1 L_cls1
    s_add_u32 s6, s15, 1
    s_and_b32 s6, s6, 7
    s_lshl_b32 s7, s6, 7
    s_add_u32 m0, s12, 0x8000
    s_add_u32 s14, s8, s7
    buffer_load_dwordx4 v10, s[32:35], s14 offen offset:0 lds
    buffer_load_dwordx4 v11, s[32:35], s14 offen offset:1024 lds
    buffer_load_dwordx4 v12, s[32:35], s14 offen offset:2048 lds
    buffer_load_dwordx4 v13, s[32:35], s14 offen offset:3072 lds
    s_waitcnt vmcnt(8)
    s_barrier
    s_add_u32 s6, s15, 2
    s_and_b32 s6, s6, 7
    s_lshl_b32 s7, s6, 7
    s_add_u32 m0, s12, 0x10000
    s_add_u32 s14, s8, s7
    buffer_load_dwordx4 v10, s[32:35], s14 offen offset:0 lds
    buffer_load_dwordx4 v11, s[32:35], s14 offen offset:1024 lds
    buffer_load_dwordx4 v12, s[32:35], s14 offen offset:2048 lds
    buffer_load_dwordx4 v13, s[32:35], s14 offen offset:3072 lds
    s_add_u32 s6, s15, 2
    s_and_b32 s6, s6, 7
    s_lshl_b32 s7, s6, 19
    s_add_u32 m0, s12, 0x14000
    s_add_u32 s14, s9, s7
    buffer_load_dwordx4 v14, s[44:47], s14 offen offset:0 lds
    buffer_load_dwordx4 v15, s[44:47], s14 offen offset:1024 lds
    buffer_load_dwordx4 v16, s[44:47], s14 offen offset:2048 lds
    buffer_load_dwordx4 v17, s[44:47], s14 offen offset:3072 lds
    s_add_u32 m0, s12, 0x20000
    s_add_u32 s14, s10, 0x0
    buffer_load_dwordx4 v18, s[36:39], s14 offen offset:0 nt lds
    buffer_load_dwordx4 v19, s[36:39], s14 offen offset:1024 nt lds
    buffer_load_dwordx4 v20, s[36:39], s14 offen offset:2048 nt lds
    buffer_load_dwordx4 v21, s[36:39], s14 offen offset:3072 nt lds
    s_waitcnt vmcnt(12)
    s_barrier
    s_add_u32 m0, s12, 0x24000
    s_add_u32 s14, s10, 0x4000
    buffer_load_dwordx4 v18, s[36:39], s14 offen offset:0 nt lds
    buffer_load_dwordx4 v19, s[36:39], s14 offen offset:1024 nt lds
    buffer_load_dwordx4 v20, s[36:39], s14 offen offset:2048 nt lds
    buffer_load_dwordx4 v21, s[36:39], s14 offen offset:3072 nt lds
    s_add_u32 s6, s15, 3
    s_and_b32 s6, s6, 7
    s_lshl_b32 s7, s6, 7
    s_add_u32 m0, s12, 0x18000
    s_add_u32 s14, s8, s7
    buffer_load_dwordx4 v10, s[32:35], s14 offen offset:0 lds
    buffer_load_dwordx4 v11, s[32:35], s14 offen offset:1024 lds
    buffer_load_dwordx4 v12, s[32:35], s14 offen offset:2048 lds
    buffer_load_dwordx4 v13, s[32:35], s14 offen offset:3072 lds
    s_waitcnt vmcnt(12)
    s_barrier
    s_add_u32 s6, s15, 3
    s_and_b32 s6, s6, 7
    s_lshl_b32 s7, s6, 19
    s_add_u32 m0, s12, 0x1c000
    s_add_u32 s14, s9, s7
    buffer_load_dwordx4 v14, s[44:47], s14 offen offset:0 lds
    buffer_load_dwordx4 v15, s[44:47], s14 offen offset:1024 lds
    buffer_load_dwordx4 v16, s[44:47], s14 offen offset:2048 lds
    buffer_load_dwordx4 v17, s[44:47], s14 offen offset:3072 lds
    s_add_u32 s6, s15, 4
    s_and_b32 s6, s6, 7
    s_lshl_b32 s7, s6, 7
    s_add_u32 m0, s12, 0x0
    s_add_u32 s14, s8, s7
    buffer_load_dwordx4 v10, s[32:35], s14 offen offset:0 lds
    buffer_load_dwordx4 v11, s[32:35], s14 offen offset:1024 lds
    buffer_load_dwordx4 v12, s[32:35], s14 offen offset:2048 lds
    buffer_load_dwordx4 v13, s[32:35], s14 offen offset:3072 lds
    s_add_u32 s6, s15, 4
    s_and_b32 s6, s6, 7
    s_lshl_b32 s7, s6, 19
    s_add_u32 m0, s12, 0x4000
    s_add_u32 s14, s9, s7
    buffer_load_dwordx4 v14, s[44:47], s14 offen offset:0 lds
    buffer_load_dwordx4 v15, s[44:47], s14 offen offset:1024 lds
    buffer_load_dwordx4 v16, s[44:47], s14 offen offset:2048 lds
    buffer_load_dwordx4 v17, s[44:47], s14 offen offset:3072 lds
    s_add_u32 s6, s15, 5
    s_and_b32 s6, s6, 7
    s_lshl_b32 s7, s6, 7
    s_add_u32 m0, s12, 0x8000
    s_add_u32 s14, s8, s7
    buffer_load_dwordx4 v10, s[32:35], s14 offen offset:0 lds
    buffer_load_dwordx4 v11, s[32:35], s14 offen offset:1024 lds
    buffer_load_dwordx4 v12, s[32:35], s14 offen offset:2048 lds
    buffer_load_dwordx4 v13, s[32:35], s14 offen offset:3072 lds
    s_waitcnt vmcnt(12)
    s_barrier
    s_add_u32 s6, s15, 5
    s_and_b32 s6, s6, 7
    s_lshl_b32 s7, s6, 19
    s_add_u32 m0, s12, 0xc000
    s_add_u32 s14, s9, s7
    buffer_load_dwordx4 v14, s[44:47], s14 offen offset:0 lds
    buffer_load_dwordx4 v15, s[44:47], s14 offen offset:1024 lds
    buffer_load_dwordx4 v16, s[44:47], s14 offen offset:2048 lds
    buffer_load_dwordx4 v17, s[44:47], s14 offen offset:3072 lds
    s_add_u32 s6, s15, 6
    s_and_b32 s6, s6, 7
    s_lshl_b32 s7, s6, 7
    s_add_u32 m0, s12, 0x10000
    s_add_u32 s14, s8, s7
    buffer_load_dwordx4 v10, s[32:35], s14 offen offset:0 lds
    buffer_load_dwordx4 v11, s[32:35], s14 offen offset:1024 lds
    buffer_load_dwordx4 v12, s[32:35], s14 offen offset:2048 lds
    buffer_load_dwordx4 v13, s[32:35], s14 offen offset:3072 lds
    s_add_u32 s6, s15, 6
    s_and_b32 s6, s6, 7
    s_lshl_b32 s7, s6, 19
    s_add_u32 m0, s12, 0x14000
    s_add_u32 s14, s9, s7
    buffer_load_dwordx4 v14, s[44:47], s14 offen offset:0 lds
    buffer_load_dwordx4 v15, s[44:47], s14 offen offset:1024 lds
    buffer_load_dwordx4 v16, s[44:47], s14 offen offset:2048 lds
    buffer_load_dwordx4 v17, s[44:47], s14 offen offset:3072 lds
    s_waitcnt vmcnt(16)
    s_barrier
    s_add_u32 s6, s15, 7
    s_and_b32 s6, s6, 7
    s_lshl_b32 s7, s6, 7
    s_add_u32 m0, s12, 0x18000
    s_add_u32 s14, s8, s7
    buffer_load_dwordx4 v10, s[32:35], s14 offen offset:0 lds
    buffer_load_dwordx4 v11, s[32:35], s14 offen offset:1024 lds
    buffer_load_dwordx4 v12, s[32:35], s14 offen offset:2048 lds
    buffer_load_dwordx4 v13, s[32:35], s14 offen offset:3072 lds
    s_add_u32 s6, s15, 7
    s_and_b32 s6, s6, 7
    s_lshl_b32 s7, s6, 19
    s_add_u32 m0, s12, 0x1c000
    s_add_u32 s14, s9, s7
    buffer_load_dwordx4 v14, s[44:47], s14 offen offset:0 lds
    buffer_load_dwordx4 v15, s[44:47], s14 offen offset:1024 lds
    buffer_load_dwordx4 v16, s[44:47], s14 offen offset:2048 lds
    buffer_load_dwordx4 v17, s[44:47], s14 offen offset:3072 lds
    s_waitcnt vmcnt(16)
    s_barrier
    s_add_u32 m0, s12, 0x0
    s_add_u32 s14, s10, 0x0
    buffer_load_dwordx4 v22, s[40:43], s14 offen offset:0 nt lds
    buffer_load_dwordx4 v22, s[40:43], s14 offen offset:1024 nt lds
    buffer_load_dwordx4 v22, s[40:43], s14 offen offset:2048 nt lds
    buffer_load_dwordx4 v22, s[40:43], s14 offen offset:3072 nt lds
    s_add_u32 m0, s12, 0x4000
    s_add_u32 s14, s10, 0x4000
    buffer_load_dwordx4 v22, s[40:43], s14 offen offset:0 nt lds
    buffer_load_dwordx4 v22, s[40:43], s14 offen offset:1024 nt lds
    buffer_load_dwordx4 v22, s[40:43], s14 offen offset:2048 nt lds
    buffer_load_dwordx4 v22, s[40:43], s14 offen offset:3072 nt lds
    s_waitcnt vmcnt(16)
    s_barrier
    s_add_u32 s6, s13, 0
    s_and_b32 s6, s6, 7
    s_lshl_b32 s6, s6, 17
    s_add_u32 m0, s12, 0x8000
    s_add_u32 s14, s11, s6
    buffer_load_dwordx4 v24, s[48:51], s14 offen offset:0 lds
    buffer_load_dwordx4 v25, s[48:51], s14 offen offset:1024 lds
    buffer_load_dwordx4 v26, s[48:51], s14 offen offset:2048 lds
    buffer_load_dwordx4 v27, s[48:51], s14 offen offset:3072 lds
    s_waitcnt vmcnt(12)
    s_barrier
    s_add_u32 s6, s13, 1
    s_and_b32 s6, s6, 7
    s_lshl_b32 s6, s6, 17
    s_add_u32 m0, s12, 0xc000
    s_add_u32 s14, s11, s6
    buffer_load_dwordx4 v24, s[48:51], s14 offen offset:0 lds
    buffer_load_dwordx4 v25, s[48:51], s14 offen offset:1024 lds
    buffer_load_dwordx4 v26, s[48:51], s14 offen offset:2048 lds
    buffer_load_dwordx4 v27, s[48:51], s14 offen offset:3072 lds
    s_barrier
    s_add_u32 s6, s13, 2
    s_and_b32 s6, s6, 7
    s_lshl_b32 s6, s6, 17
    s_add_u32 m0, s12, 0x10000
    s_add_u32 s14, s11, s6
    buffer_load_dwordx4 v24, s[48:51], s14 offen offset:0 lds
    buffer_load_dwordx4 v25, s[48:51], s14 offen offset:1024 lds
    buffer_load_dwordx4 v26, s[48:51], s14 offen offset:2048 lds
    buffer_load_dwordx4 v27, s[48:51], s14 offen offset:3072 lds
    s_add_u32 s6, s13, 3
    s_and_b32 s6, s6, 7
    s_lshl_b32 s6, s6, 17
    s_add_u32 m0, s12, 0x14000
    s_add_u32 s14, s11, s6
    buffer_load_dwordx4 v24, s[48:51], s14 offen offset:0 lds
    buffer_load_dwordx4 v25, s[48:51], s14 offen offset:1024 lds
    buffer_load_dwordx4 v26, s[48:51], s14 offen offset:2048 lds
    buffer_load_dwordx4 v27, s[48:51], s14 offen offset:3072 lds
    s_waitcnt vmcnt(16)
    s_barrier
    s_add_u32 s6, s13, 4
    s_and_b32 s6, s6, 7
    s_lshl_b32 s6, s6, 17
    s_add_u32 m0, s12, 0x18000
    s_add_u32 s14, s11, s6
    buffer_load_dwordx4 v24, s[48:51], s14 offen offset:0 lds
    buffer_load_dwordx4 v25, s[48:51], s14 offen offset:1024 lds
    buffer_load_dwordx4 v26, s[48:51], s14 offen offset:2048 lds
    buffer_load_dwordx4 v27, s[48:51], s14 offen offset:3072 lds
    s_add_u32 s6, s13, 5
    s_and_b32 s6, s6, 7
    s_lshl_b32 s6, s6, 17
    s_add_u32 m0, s12, 0x1c000
    s_add_u32 s14, s11, s6
    buffer_load_dwordx4 v24, s[48:51], s14 offen offset:0 lds
    buffer_load_dwordx4 v25, s[48:51], s14 offen offset:1024 lds
    buffer_load_dwordx4 v26, s[48:51], s14 offen offset:2048 lds
    buffer_load_dwordx4 v27, s[48:51], s14 offen offset:3072 lds
    s_add_u32 s6, s13, 6
    s_and_b32 s6, s6, 7
    s_lshl_b32 s6, s6, 17
    s_add_u32 m0, s12, 0x20000
    s_add_u32 s14, s11, s6
    buffer_load_dwordx4 v24, s[48:51], s14 offen offset:0 lds
    buffer_load_dwordx4 v25, s[48:51], s14 offen offset:1024 lds
    buffer_load_dwordx4 v26, s[48:51], s14 offen offset:2048 lds
    buffer_load_dwordx4 v27, s[48:51], s14 offen offset:3072 lds
    s_add_u32 s6, s13, 7
    s_and_b32 s6, s6, 7
    s_lshl_b32 s6, s6, 17
    s_add_u32 m0, s12, 0x24000
    s_add_u32 s14, s11, s6
    buffer_load_dwordx4 v24, s[48:51], s14 offen offset:0 lds
    buffer_load_dwordx4 v25, s[48:51], s14 offen offset:1024 lds
    buffer_load_dwordx4 v26, s[48:51], s14 offen offset:2048 lds
    buffer_load_dwordx4 v27, s[48:51], s14 offen offset:3072 lds
    s_waitcnt vmcnt(0)
    s_barrier
    s_endpgm
L_cls1:
    s_add_u32 s6, s15, 1
    s_and_b32 s6, s6, 7
    s_lshl_b32 s7, s6, 7
    s_add_u32 m0, s12, 0x8000
    s_add_u32 s14, s8, s7
    buffer_load_dwordx4 v10, s[32:35], s14 offen offset:0 lds
    buffer_load_dwordx4 v11, s[32:35], s14 offen offset:1024 lds
    buffer_load_dwordx4 v12, s[32:35], s14 offen offset:2048 lds
    buffer_load_dwordx4 v13, s[32:35], s14 offen offset:3072 lds
    s_waitcnt vmcnt(8)
    s_barrier
    s_add_u32 s6, s15, 2
    s_and_b32 s6, s6, 7
    s_lshl_b32 s7, s6, 7
    s_add_u32 m0, s12, 0x10000
    s_add_u32 s14, s8, s7
    buffer_load_dwordx4 v10, s[32:35], s14 offen offset:0 lds
    buffer_load_dwordx4 v11, s[32:35], s14 offen offset:1024 lds
    buffer_load_dwordx4 v12, s[32:35], s14 offen offset:2048 lds
    buffer_load_dwordx4 v13, s[32:35], s14 offen offset:3072 lds
    s_add_u32 s6, s15, 2
    s_and_b32 s6, s6, 7
    s_lshl_b32 s7, s6, 19
    s_add_u32 m0, s12, 0x14000
    s_add_u32 s14, s9, s7
    buffer_load_dwordx4 v14, s[44:47], s14 offen offset:0 lds
    buffer_load_dwordx4 v15, s[44:47], s14 offen offset:1024 lds
    buffer_load_dwordx4 v16, s[44:47], s14 offen offset:2048 lds
    buffer_load_dwordx4 v17, s[44:47], s14 offen offset:3072 lds
    s_add_u32 s6, s15, 3
    s_and_b32 s6, s6, 7
    s_lshl_b32 s7, s6, 7
    s_add_u32 m0, s12, 0x18000
    s_add_u32 s14, s8, s7
    buffer_load_dwordx4 v10, s[32:35], s14 offen offset:0 lds
    buffer_load_dwordx4 v11, s[32:35], s14 offen offset:1024 lds
    buffer_load_dwordx4 v12, s[32:35], s14 offen offset:2048 lds
    buffer_load_dwordx4 v13, s[32:35], s14 offen offset:3072 lds
    s_waitcnt vmcnt(12)
    s_barrier
    s_add_u32 s6, s15, 3
    s_and_b32 s6, s6, 7
    s_lshl_b32 s7, s6, 19
    s_add_u32 m0, s12, 0x1c000
    s_add_u32 s14, s9, s7
    buffer_load_dwordx4 v14, s[44:47], s14 offen offset:0 lds
    buffer_load_dwordx4 v15, s[44:47], s14 offen offset:1024 lds
    buffer_load_dwordx4 v16, s[44:47], s14 offen offset:2048 lds
    buffer_load_dwordx4 v17, s[44:47], s14 offen offset:3072 lds
    s_add_u32 s6, s15, 4
    s_and_b32 s6, s6, 7
    s_lshl_b32 s7, s6, 7
    s_add_u32 m0, s12, 0x0
    s_add_u32 s14, s8, s7
    buffer_load_dwordx4 v10, s[32:35], s14 offen offset:0 lds
    buffer_load_dwordx4 v11, s[32:35], s14 offen offset:1024 lds
    buffer_load_dwordx4 v12, s[32:35], s14 offen offset:2048 lds
    buffer_load_dwordx4 v13, s[32:35], s14 offen offset:3072 lds
    s_add_u32 s6, s15, 4
    s_and_b32 s6, s6, 7
    s_lshl_b32 s7, s6, 19
    s_add_u32 m0, s12, 0x4000
    s_add_u32 s14, s9, s7
    buffer_load_dwordx4 v14, s[44:47], s14 offen offset:0 lds
    buffer_load_dwordx4 v15, s[44:47], s14 offen offset:1024 lds
    buffer_load_dwordx4 v16, s[44:47], s14 offen offset:2048 lds
    buffer_load_dwordx4 v17, s[44:47], s14 offen offset:3072 lds
    s_waitcnt vmcnt(16)
    s_barrier
    s_add_u32 s6, s15, 5
    s_and_b32 s6, s6, 7
    s_lshl_b32 s7, s6, 7
    s_add_u32 m0, s12, 0x8000
    s_add_u32 s14, s8, s7
    buffer_load_dwordx4 v10, s[32:35], s14 offen offset:0 lds
    buffer_load_dwordx4 v11, s[32:35], s14 offen offset:1024 lds
    buffer_load_dwordx4 v12, s[32:35], s14 offen offset:2048 lds
    buffer_load_dwordx4 v13, s[32:35], s14 offen offset:3072 lds
    s_add_u32 s6, s15, 5
    s_and_b32 s6, s6, 7
    s_lshl_b32 s7, s6, 19
    s_add_u32 m0, s12, 0xc000
    s_add_u32 s14, s9, s7
    buffer_load_dwordx4 v14, s[44:47], s14 offen offset:0 lds
    buffer_load_dwordx4 v15, s[44:47], s14 offen offset:1024 lds
    buffer_load_dwordx4 v16, s[44:47], s14 offen offset:2048 lds
    buffer_load_dwordx4 v17, s[44:47], s14 offen offset:3072 lds
    s_waitcnt vmcnt(16)
    s_barrier
    s_add_u32 s6, s15, 6
    s_and_b32 s6, s6, 7
    s_lshl_b32 s7, s6, 7
    s_add_u32 m0, s12, 0x10000
    s_add_u32 s14, s8, s7
    buffer_load_dwordx4 v10, s[32:35], s14 offen offset:0 lds
    buffer_load_dwordx4 v11, s[32:35], s14 offen offset:1024 lds
    buffer_load_dwordx4 v12, s[32:35], s14 offen offset:2048 lds
    buffer_load_dwordx4 v13, s[32:35], s14 offen offset:3072 lds
    s_add_u32 s6, s15, 6
    s_and_b32 s6, s6, 7
    s_lshl_b32 s7, s6, 19
    s_add_u32 m0, s12, 0x14000
    s_add_u32 s14, s9, s7
    buffer_load_dwordx4 v14, s[44:47], s14 offen offset:0 lds
    buffer_load_dwordx4 v15, s[44:47], s14 offen offset:1024 lds
    buffer_load_dwordx4 v16, s[44:47], s14 offen offset:2048 lds
    buffer_load_dwordx4 v17, s[44:47], s14 offen offset:3072 lds
    s_add_u32 m0, s12, 0x20000
    s_add_u32 s14, s10, 0x0
    buffer_load_dwordx4 v18, s[36:39], s14 offen offset:0 nt lds
    buffer_load_dwordx4 v19, s[36:39], s14 offen offset:1024 nt lds
    buffer_load_dwordx4 v20, s[36:39], s14 offen offset:2048 nt lds
    buffer_load_dwordx4 v21, s[36:39], s14 offen offset:3072 nt lds
    s_waitcnt vmcnt(20)
    s_barrier
    s_add_u32 m0, s12, 0x24000
    s_add_u32 s14, s10, 0x4000
    buffer_load_dwordx4 v18, s[36:39], s14 offen offset:0 nt lds
    buffer_load_dwordx4 v19, s[36:39], s14 offen offset:1024 nt lds
    buffer_load_dwordx4 v20, s[36:39], s14 offen offset:2048 nt lds
    buffer_load_dwordx4 v21, s[36:39], s14 offen offset:3072 nt lds
    s_add_u32 s6, s15, 7
    s_and_b32 s6, s6, 7
    s_lshl_b32 s7, s6, 7
    s_add_u32 m0, s12, 0x18000
    s_add_u32 s14, s8, s7
    buffer_load_dwordx4 v10, s[32:35], s14 offen offset:0 lds
    buffer_load_dwordx4 v11, s[32:35], s14 offen offset:1024 lds
    buffer_load_dwordx4 v12, s[32:35], s14 offen offset:2048 lds
    buffer_load_dwordx4 v13, s[32:35], s14 offen offset:3072 lds
    s_waitcnt vmcnt(20)
    s_barrier
    s_add_u32 s6, s15, 7
    s_and_b32 s6, s6, 7
    s_lshl_b32 s7, s6, 19
    s_add_u32 m0, s12, 0x1c000
    s_add_u32 s14, s9, s7
    buffer_load_dwordx4 v14, s[44:47], s14 offen offset:0 lds
    buffer_load_dwordx4 v15, s[44:47], s14 offen offset:1024 lds
    buffer_load_dwordx4 v16, s[44:47], s14 offen offset:2048 lds
    buffer_load_dwordx4 v17, s[44:47], s14 offen offset:3072 lds
    s_add_u32 m0, s12, 0x0
    s_add_u32 s14, s10, 0x0
    buffer_load_dwordx4 v22, s[40:43], s14 offen offset:0 nt lds
    buffer_load_dwordx4 v22, s[40:43], s14 offen offset:1024 nt lds
    buffer_load_dwordx4 v22, s[40:43], s14 offen offset:2048 nt lds
    buffer_load_dwordx4 v22, s[40:43], s14 offen offset:3072 nt lds
    s_add_u32 m0, s12, 0x4000
    s_add_u32 s14, s10, 0x4000
    buffer_load_dwordx4 v22, s[40:43], s14 offen offset:0 nt lds
    buffer_load_dwordx4 v22, s[40:43], s14 offen offset:1024 nt lds
    buffer_load_dwordx4 v22, s[40:43], s14 offen offset:2048 nt lds
    buffer_load_dwordx4 v22, s[40:43], s14 offen offset:3072 nt lds
    s_waitcnt vmcnt(24)
    s_barrier
    s_waitcnt vmcnt(8)
    s_barrier
    s_add_u32 s6, s13, 0
    s_and_b32 s6, s6, 7
    s_lshl_b32 s6, s6, 17
    s_add_u32 m0, s12, 0x8000
    s_add_u32 s14, s11, s6
    buffer_load_dwordx4 v24, s[48:51], s14 offen offset:0 lds
    buffer_load_dwordx4 v25, s[48:51], s14 offen offset:1024 lds
    buffer_load_dwordx4 v26, s[48:51], s14 offen offset:2048 lds
    buffer_load_dwordx4 v27, s[48:51], s14 offen offset:3072 lds
    s_barrier
    s_add_u32 s6, s13, 1
    s_and_b32 s6, s6, 7
    s_lshl_b32 s6, s6, 17
    s_add_u32 m0, s12, 0xc000
    s_add_u32 s14, s11, s6
    buffer_load_dwordx4 v24, s[48:51], s14 offen offset:0 lds
    buffer_load_dwordx4 v25, s[48:51], s14 offen offset:1024 lds
    buffer_load_dwordx4 v26, s[48:51], s14 offen offset:2048 lds
    buffer_load_dwordx4 v27, s[48:51], s14 offen offset:3072 lds
    s_add_u32 s6, s13, 2
    s_and_b32 s6, s6, 7
    s_lshl_b32 s6, s6, 17
    s_add_u32 m0, s12, 0x10000
    s_add_u32 s14, s11, s6
    buffer_load_dwordx4 v24, s[48:51], s14 offen offset:0 lds
    buffer_load_dwordx4 v25, s[48:51], s14 offen offset:1024 lds
    buffer_load_dwordx4 v26, s[48:51], s14 offen offset:2048 lds
    buffer_load_dwordx4 v27, s[48:51], s14 offen offset:3072 lds
    s_waitcnt vmcnt(12)
    s_barrier
    s_add_u32 s6, s13, 3
    s_and_b32 s6, s6, 7
    s_lshl_b32 s6, s6, 17
    s_add_u32 m0, s12, 0x14000
    s_add_u32 s14, s11, s6
    buffer_load_dwordx4 v24, s[48:51], s14 offen offset:0 lds
    buffer_load_dwordx4 v25, s[48:51], s14 offen offset:1024 lds
    buffer_load_dwordx4 v26, s[48:51], s14 offen offset:2048 lds
    buffer_load_dwordx4 v27, s[48:51], s14 offen offset:3072 lds
    s_add_u32 s6, s13, 4
    s_and_b32 s6, s6, 7
    s_lshl_b32 s6, s6, 17
    s_add_u32 m0, s12, 0x18000
    s_add_u32 s14, s11, s6
    buffer_load_dwordx4 v24, s[48:51], s14 offen offset:0 lds
    buffer_load_dwordx4 v25, s[48:51], s14 offen offset:1024 lds
    buffer_load_dwordx4 v26, s[48:51], s14 offen offset:2048 lds
    buffer_load_dwordx4 v27, s[48:51], s14 offen offset:3072 lds
    s_add_u32 s6, s13, 5
    s_and_b32 s6, s6, 7
    s_lshl_b32 s6, s6, 17
    s_add_u32 m0, s12, 0x1c000
    s_add_u32 s14, s11, s6
    buffer_load_dwordx4 v24, s[48:51], s14 offen offset:0 lds
    buffer_load_dwordx4 v25, s[48:51], s14 offen offset:1024 lds
    buffer_load_dwordx4 v26, s[48:51], s14 offen offset:2048 lds
    buffer_load_dwordx4 v27, s[48:51], s14 offen offset:3072 lds
    s_add_u32 s6, s13, 6
    s_and_b32 s6, s6, 7
    s_lshl_b32 s6, s6, 17
    s_add_u32 m0, s12, 0x20000
    s_add_u32 s14, s11, s6
    buffer_load_dwordx4 v24, s[48:51], s14 offen offset:0 lds
    buffer_load_dwordx4 v25, s[48:51], s14 offen offset:1024 lds
    buffer_load_dwordx4 v26, s[48:51], s14 offen offset:2048 lds
    buffer_load_dwordx4 v27, s[48:51], s14 offen offset:3072 lds
    s_add_u32 s6, s13, 7
    s_and_b32 s6, s6, 7
    s_lshl_b32 s6, s6, 17
    s_add_u32 m0, s12, 0x24000
    s_add_u32 s14, s11, s6
    buffer_load_dwordx4 v24, s[48:51], s14 offen offset:0 lds
    buffer_load_dwordx4 v25, s[48:51], s14 offen offset:1024 lds
    buffer_load_dwordx4 v26, s[48:51], s14 offen offset:2048 lds
    buffer_load_dwordx4 v27, s[48:51], s14 offen offset:3072 lds
    s_waitcnt vmcnt(0)
    s_barrier
    s_endpgm
L_code_end:
.section .rodata,"a"
.p2align 6
.amdhsa_kernel standalone__mha_block_cached__near_ridge_kernel
  .amdhsa_next_free_vgpr 256
  .amdhsa_next_free_sgpr 102
  .amdhsa_accum_offset 256
  .amdhsa_group_segment_fixed_size 0
  .amdhsa_kernarg_size 64
  .amdhsa_user_sgpr_count 2
  .amdhsa_user_sgpr_kernarg_segment_ptr 1
  .amdhsa_system_sgpr_workgroup_id_x 1
.end_amdhsa_kernel
```
